```python
import torch

def _softmax(x, axis=-1):
    return torch.softmax(x, dim=axis)

def _gelu(x):
    return torch.nn.functional.gelu(x, approximate='tanh')

def _silu(x):
    return torch.nn.functional.silu(x)

def _sigmoid(x):
    return torch.sigmoid(x)

def _layernorm(x, axis=-1, eps=1e-05):
    m = x.mean(dim=axis, keepdim=True)
    v = x.var(dim=axis, keepdim=True, unbiased=False)
    return (x - m) / torch.sqrt(v + eps)

def _scatter_add(tgt, idx, src, axis=0):
    return tgt.clone().index_add_(axis, idx, src)

def _segment_sum(src, seg, n):
    out = torch.zeros((n,) + src.shape[1:], dtype=src.dtype)
    return out.index_add_(0, seg, src)

def _pad(x, pw):
    flat = tuple((v for pair in reversed(pw) for v in pair))
    return torch.nn.functional.pad(x, flat)
kernel_name = 'adaLN_cond__ssm_conv_h3__glu_gated_geglu__prompt'

def setup_inputs():

    _w = lambda a: (lambda t: t.to(torch.bfloat16) if t.is_floating_point() else t)(torch.as_tensor(a))

    def _A_setup():
        B, S, D = (1, 2048, 512)
        ks = 4
        return {'q': _w((lambda *s: torch.randn(*s, dtype=torch.bfloat16) * 0.05)(B, S, D)), 'k': _w((lambda *s: torch.randn(*s, dtype=torch.bfloat16) * 1.6)(B, S, D)), 'v': _w((lambda *s: torch.randn(*s, dtype=torch.bfloat16) * 1.6)(B, S, D)), 'shift_k': _w((lambda *s: torch.randn(*s, dtype=torch.bfloat16) * 1.6)(D, ks) * 0.5), 'ssm_k': _w((lambda *s: torch.randn(*s, dtype=torch.bfloat16) * 1.6)(D, S) * (1.0 / S ** 0.5)), 'ssm_D': _w((lambda *s: torch.randn(*s, dtype=torch.bfloat16) * 1.6)(D))}
    _A_in = _A_setup()

    def _B_setup():
        B, S, Dm, Df = (1, 2048, 512, 1792)
        return {'x': _w((lambda *s: torch.randn(*s, dtype=torch.bfloat16) * 0.05)(B, S, Dm)), 'w_gate': _w((lambda *s: torch.randn(*s, dtype=torch.bfloat16) * 3.2)(Dm, Df) * Dm ** (-0.5)), 'w_up': _w((lambda *s: torch.randn(*s, dtype=torch.bfloat16) * 3.2)(Dm, Df) * Dm ** (-0.5)), 'w_down': _w((lambda *s: torch.randn(*s, dtype=torch.bfloat16) * 3.2)(Df, Dm) * Df ** (-0.5))}
    _B_in = _B_setup()
    return {'A_q': _A_in['q'], 'A_k': _A_in['k'], 'A_v': _A_in['v'], 'A_shift_k': _A_in['shift_k'], 'A_ssm_k': _A_in['ssm_k'], 'A_ssm_D': _A_in['ssm_D'], 'B_x': _B_in['x'], 'B_w_gate': _B_in['w_gate'], 'B_w_up': _B_in['w_up'], 'B_w_down': _B_in['w_down'], 'c': _w((lambda *s: torch.randn(*s, dtype=torch.bfloat16) * 0.1)(1, 512) * 8.0), 'w_mod': _w((lambda *s: torch.randn(*s, dtype=torch.bfloat16) * 0.1)(512, 6 * 512) * 512 ** (-0.5) * 8.0)}

def reference(A_q, A_k, A_v, A_shift_k, A_ssm_k, A_ssm_D, B_x, B_w_gate, B_w_up, B_w_down, c, w_mod):

    def _A_ref(q, k, v, shift_k, ssm_k, ssm_D):
        B, S, D = q.shape
        ks = shift_k.shape[-1]
        k_pad = _pad(k, ((0, 0), (ks - 1, 0), (0, 0)))
        k_shift = torch.zeros_like(k)
        for t in range(ks):
            k_shift = k_shift + k_pad[:, t:t + S, :] * shift_k[:, ks - 1 - t][None, None, :]
        kv = k_shift * v
        L = 2 * S
        kv_pad = _pad(kv, ((0, 0), (0, S), (0, 0)))
        kf_pad = _pad(ssm_k, ((0, 0), (0, S)))
        kv_f = (lambda x, axes=(-2, -1): torch.fft.rfft2(x.float(), dim=axes))(kv_pad[:, None, :, :], axes=(1, 2))
        kf_f = (lambda x, axes=(-2, -1): torch.fft.rfft2(x.float(), dim=axes))(kf_pad[:, None, :], axes=(1, 2))
        kf_f = (lambda x, *d: x.permute(*d))(kf_f, 1, 2, 0)
        y_f = kv_f * kf_f[None, :, :, :]
        y = (lambda x, s, axes=(-2, -1): torch.fft.irfft2(x, s=s, dim=axes).to(torch.bfloat16))(y_f, (1, L), axes=(1, 2))[:, 0, :S, :]
        y = y + kv * ssm_D[None, None, :]
        return q * y

    def _B_ref(x, w_gate, w_up, w_down):
        g = torch.einsum('bsd,df->bsf', x, w_gate)
        u = torch.einsum('bsd,df->bsf', x, w_up)
        h = _gelu(g) * u
        return torch.einsum('bsf,fd->bsd', h, w_down)
    x = A_q
    mod = (_silu(c) @ w_mod).reshape(c.shape[0], 6, 1, -1)
    sa, ca, ga, sb, cb, gb = (mod[:, 0].clone(), mod[:, 1].clone(), mod[:, 2].clone(), mod[:, 3].clone(), mod[:, 4].clone(), mod[:, 5].clone())
    h = _layernorm(x, axis=-1) * (1 + ca) + sa
    x = x + ga * _A_ref(h, A_k, A_v, A_shift_k, A_ssm_k, A_ssm_D)
    h = _layernorm(x, axis=-1) * (1 + cb) + sb
    x = x + gb * _B_ref(h, B_w_gate, B_w_up, B_w_down)
    return x
```

```asm
; @launch grid=(256,1,1) block=(512,1,1) lds=163840
.amdgcn_target "amdgcn-amd-amdhsa--gfx950"
.text
.globl adaLN_cond__ssm_conv_h3__glu_gated_geglu__prompt_kernel
.p2align 8
.type adaLN_cond__ssm_conv_h3__glu_gated_geglu__prompt_kernel,@function
adaLN_cond__ssm_conv_h3__glu_gated_geglu__prompt_kernel:
    s_load_dwordx16 s[4:19], s[0:1], 0
    s_cmpk_ge_u32 s2, 0x100
    s_cbranch_scc1 L_end
    s_lshr_b32 s86, s2, 3
    s_getpc_b64 s[34:35]
L_here:
    s_mul_i32 s3, s86, ((L_last-L_here-1024)>>8)<<3
    v_lshl_add_u32 v2, v0, 1, s3
    global_load_ushort v84, v2, s[34:35]
    v_readfirstlane_b32 s84, v0
    s_and_b32 s85, s2, 7
    s_lshl_b32 s3, s86, 12
    s_lshl3_add_u32 s3, s85, s3
    v_lshrrev_b32 v4, 3, v0
    v_and_b32 v5, 2, v4
    v_bitop3_b32 v5, v5, v0, 7 bitop3:0x28
    v_lshl_add_u32 v4, v4, 6, v5
    v_add_lshl_u32 v4, v4, s3, 4
    s_lshl4_add_u32 m0, s84, 66560
    s_waitcnt lgkmcnt(0)
    global_load_lds_dwordx4 v4, s[6:7]
    s_addk_i32 m0, 0x2000
    v_and_b32 v1, 63, v0
    global_load_lds_dwordx4 v4, s[8:9] nt
    s_load_dwordx8 s[20:27], s[0:1], 64
    s_load_dwordx4 s[28:31], s[0:1], 96
    s_load_dwordx2 s[32:33], s[0:1], 112
    s_mov_b32 s40, s6
    s_mov_b32 s41, s7
    s_mov_b32 s42, 0x200000
    s_mov_b32 s43, 0x20000
    s_cmp_eq_u32 s84, 64
    s_cbranch_scc0 L_skip_1
    v_subrev_u32 v5, 16384, v4
    s_mov_b32 m0, 65536
    s_mov_b32 exec_lo, 0
    buffer_load_dwordx4 v5, s[40:43], 0 offen lds
    s_mov_b32 exec_lo, -1
L_skip_1:
    v_bfe_u32 v6, v0, 6, 2
    v_and_b32 v7, 15, v0
    v_lshl_add_u32 v10, v6, 4, v7
    s_lshl_b32 s92, s85, 9
    v_lshl_add_u32 v7, v10, 3, s92
    global_load_dwordx2 v[36:37], v7, s[10:11]
    s_lshr_b32 s84, s84, 6
    s_lshl_b32 s87, s85, 5
    s_add_u32 s87, s87, s86
    s_mov_b32 s34, s85
    s_mov_b32 s35, s86
    s_mov_b32 s52, s12
    s_mov_b32 s53, s13
    s_mov_b32 s54, 0x200000
    s_mov_b32 s55, 0x20000
    s_lshl_b32 s90, s87, 13
    v_lshl_add_u32 v9, v0, 4, s90
    v_subrev_u32 v38, 8, v9
    v_and_b32 v11, 255, v0
    v_cmp_eq_u32 vcc, 0, v11
    v_mov_b32 v11, 0x80000000
    s_nop 0
    v_cndmask_b32 v38, v38, v11, vcc
    v_mov_b32 v60, 0
    v_mov_b32 v61, 0
    v_mov_b32 v80, -1
    v_mov_b32 v81, -1
    v_mov_b32 v82, -1
    v_mov_b32 v83, -1
    v_bfe_u32 v2, v1, 3, 1
    v_xor_b32 v6, v6, v2
    v_lshlrev_b32 v6, 5, v6
    v_and_b32 v2, 3, v1
    v_lshl_add_u32 v6, v2, 3, v6
    v_bfe_u32 v2, v1, 2, 2
    v_lshl_add_u32 v6, v2, 7, v6
    v_lshrrev_b32 v2, 4, v1
    s_and_b32 s90, s84, 4
    v_add_u32 v2, s90, v2
    v_lshl_add_u32 v6, v2, 10, v6
    v_add_u32 v6, 65536, v6
    v_lshl_add_u32 v2, s86, 3, v2
    v_lshrrev_b32 v3, 1, v10
    v_lshl_add_u32 v2, v3, 2, v2
    v_and_b32 v2, 255, v2
    v_and_b32 v8, 1, v10
    v_lshl_add_u32 v2, v2, 1, v8
    s_lshl_b32 s90, s85, 18
    v_lshl_add_u32 v3, v3, 13, s90
    v_lshl_add_u32 v8, v2, 4, v3
    s_waitcnt lgkmcnt(0)
    s_mov_b32 s76, s32
    s_mov_b32 s77, s33
    s_mov_b32 s78, 0x1000000
    s_mov_b32 s79, 0x20000
    buffer_load_dword v126, off, s[76:79], 0 sc1
    s_lshl_b32 s90, s84, 3
    s_add_u32 s90, s90, s85
    s_lshl_b32 s90, s90, 8
    s_add_u32 s90, s90, 0x4f000
    s_cmp_eq_u32 s86, 31
    s_cselect_b32 s90, s90, 0x40000000
    s_lshl_b32 s91, s87, 8
    s_mul_i32 s92, s84, 196608
    s_add_u32 s91, s91, s92
    s_add_u32 s91, s91, 0x10000
    s_cmp_lt_u32 s84, 2
    s_cselect_b32 s90, s91, s90
    v_lshlrev_b32 v2, 2, v1
    buffer_store_dword v80, v2, s[76:79], s90 offen sc1
    s_mov_b32 s36, s4
    s_mov_b32 s37, s5
    s_mov_b32 s38, 0x200000
    s_mov_b32 s39, 0x20000
    s_mov_b32 s68, s26
    s_mov_b32 s69, s27
    s_mov_b32 s70, 0x300000
    s_mov_b32 s71, 0x20000
    s_mov_b32 s80, s24
    s_mov_b32 s81, s25
    s_mov_b32 s82, 0x400
    s_mov_b32 s83, 0x20000
    s_mov_b32 s56, s18
    s_mov_b32 s57, s19
    s_mov_b32 s58, 0x1c0000
    s_mov_b32 s59, 0x20000
    s_mov_b32 s60, s20
    s_mov_b32 s61, s21
    s_mov_b32 s62, 0x1c0000
    s_mov_b32 s63, 0x20000
    s_mov_b32 s64, s22
    s_mov_b32 s65, s23
    s_mov_b32 s66, 0x1c0000
    s_mov_b32 s67, 0x20000
    s_mov_b32 s72, s28
    s_mov_b32 s73, s29
    s_mov_b32 s74, 0x200000
    s_mov_b32 s75, 0x20000
    s_lshl_b32 s90, s87, 3
    s_add_u32 s90, s90, s84
    s_lshl_b32 s90, s90, 10
    v_lshl_add_u32 v13, v1, 4, s90
    s_lshr_b32 s90, s35, 2
    s_lshl_b32 s90, s90, 10
    s_lshl_b32 s91, s34, 7
    s_add_u32 s90, s90, s91
    s_and_b32 s91, s35, 3
    s_lshl_b32 s91, s91, 7
    v_lshrrev_b32 v14, 3, v0
    v_add_u32 v14, s91, v14
    v_mul_u32_u24 v15, 6144, v14
    v_and_b32 v11, 7, v0
    v_lshl_add_u32 v15, v11, 4, v15
    s_cmp_lt_u32 s86, 24
    s_cselect_b32 s90, s90, 0x40000000
    v_add_u32 v15, s90, v15
    v_add_u32 v12, 393216, v15
    v_lshlrev_b32 v14, 1, v14
    s_barrier
    buffer_load_dwordx4 v[44:47], v9, s[52:55], 0 offen
    buffer_load_dwordx2 v[42:43], v38, s[52:55], 0 offen
    v_mov_b32 v64, 0
    v_mov_b32 v65, 0
    v_mov_b32 v66, 0
    v_mov_b32 v67, 0
    s_cmp_eq_u32 s84, 0
    s_cbranch_scc0 L_skip_2
    v_lshrrev_b32 v2, 1, v1
    v_mul_u32_u24 v2, 4160, v2
    v_and_b32 v3, 1, v1
    v_lshl_add_u32 v2, v3, 4, v2
    s_mov_b64 exec, 0xffff
    ds_write_b128 v2, v[64:67]
    s_mov_b64 exec, -1
    v_and_b32 v2, 31, v1
    v_lshlrev_b32 v2, 4, v2
    v_lshrrev_b32 v3, 5, v1
    v_mul_u32_u24 v3, 4672, v3
    v_add_u32 v2, v2, v3
    ds_write_b128 v2, v[64:67] offset:33280
L_skip_2:
    s_and_b32 s90, s85, 3
    s_mul_i32 s90, s90, 28
    s_add_u32 s90, s90, s86
    s_and_b32 s95, s90, 7
    s_lshr_b32 s96, s90, 3
    s_lshr_b32 s90, s85, 2
    s_lshl_b32 s90, s90, 3
    s_add_u32 s95, s95, s90
    s_mul_i32 s4, s95, 2
    s_and_b32 s4, s4, 7
    s_lshl_b32 s90, s85, 2
    s_and_b32 s91, s86, 3
    s_add_u32 s97, s90, s91
    s_lshr_b32 s98, s86, 2
    s_xor_b32 s98, s98, 4
    s_lshl_b32 s5, s87, 7
    s_lshl_b32 s6, s95, 4
    s_add_u32 s6, s6, s96
    s_lshl_b32 s6, s6, 7
    s_lshl_b32 s7, s96, 8
    s_cmp_lt_u32 s86, 28
    s_cselect_b32 s6, s6, 0x40000000
    s_cselect_b32 s7, s7, 0x40000000
    s_cmp_eq_u32 s84, 0
    s_cselect_b32 s5, s5, 0x40000000
    s_cselect_b32 s6, s6, 0x40000000
    s_and_b32 s99, s84, 1
    s_lshr_b32 s3, s84, 1
    v_lshrrev_b32 v2, 4, v1
    v_bfe_u32 v3, v1, 1, 3
    v_lshlrev_b32 v11, 1, v2
    v_sub_u32 v3, v3, v11
    v_mul_u32_u24 v2, 3584, v2
    v_and_b32 v11, 1, v1
    v_lshl_add_u32 v2, v11, 4, v2
    v_and_b32 v11, 7, v3
    v_lshl_add_u32 v120, v11, 5, v2
    v_subrev_u32 v3, 1, v3
    v_and_b32 v3, 7, v3
    v_lshl_add_u32 v121, v3, 5, v2
    v_bfe_u32 v2, v1, 4, 1
    v_bfe_u32 v3, v1, 2, 2
    v_lshl_add_u32 v11, v3, 1, v2
    v_add_u32 v11, s84, v11
    v_and_b32 v11, 7, v11
    v_lshlrev_b32 v11, 5, v11
    v_lshl_add_u32 v11, v3, 8, v11
    v_lshl_add_u32 v11, v2, 10, v11
    v_lshrrev_b32 v3, 5, v1
    v_lshl_add_u32 v11, v3, 12, v11
    v_and_b32 v2, 1, v1
    v_lshl_add_u32 v11, v2, 4, v11
    v_bfe_u32 v2, v1, 1, 1
    v_lshl_add_u32 v122, v2, 3, v11
    buffer_load_dwordx4 v[52:55], v15, s[68:71], 0 offen nt
    buffer_load_short_d16_hi v60, v14, s[80:83], 0 offen
    buffer_load_short_d16_hi v61, v14, s[80:83], 0 offen offset:128
    s_waitcnt vmcnt(7)
    s_barrier
    ds_read_b64_tr_b16 v[108:109], v6 offset:512
    ds_read_b64_tr_b16 v[110:111], v6 offset:1024
    ds_read_b64_tr_b16 v[112:113], v6 offset:1536
    ds_read_b64_tr_b16 v[114:115], v6 offset:9216
    ds_read_b64_tr_b16 v[116:117], v6 offset:9728
    v_and_b32 v65, 0xffff0000, v36
    v_lshlrev_b32 v64, 16, v36
    v_and_b32 v67, 0xffff0000, v37
    v_lshlrev_b32 v66, 16, v37
    s_waitcnt lgkmcnt(4)
    v_and_b32 v16, 0xffff0000, v108
    v_and_b32 v18, 0xffff0000, v109
    v_lshlrev_b32 v17, 16, v109
    s_waitcnt lgkmcnt(3)
    v_and_b32 v20, 0xffff0000, v110
    v_lshlrev_b32 v19, 16, v110
    v_and_b32 v22, 0xffff0000, v111
    v_lshlrev_b32 v21, 16, v111
    s_waitcnt lgkmcnt(2)
    v_and_b32 v24, 0xffff0000, v112
    v_lshlrev_b32 v23, 16, v112
    v_and_b32 v26, 0xffff0000, v113
    v_lshlrev_b32 v25, 16, v113
    s_waitcnt lgkmcnt(1)
    v_and_b32 v28, 0xffff0000, v114
    v_lshlrev_b32 v27, 16, v114
    v_and_b32 v30, 0xffff0000, v115
    v_lshlrev_b32 v29, 16, v115
    s_waitcnt lgkmcnt(0)
    v_and_b32 v32, 0xffff0000, v116
    v_lshlrev_b32 v31, 16, v116
    v_and_b32 v34, 0xffff0000, v117
    v_lshlrev_b32 v33, 16, v117
    v_mul_f32 v68, v19, v64
    v_mul_f32 v69, v20, v64
    v_mul_f32 v70, v21, v64
    v_mul_f32 v71, v22, v64
    v_mul_f32 v72, v23, v64
    v_mul_f32 v73, v24, v64
    v_mul_f32 v74, v25, v64
    v_mul_f32 v75, v26, v64
    v_fmac_f32 v68, v18, v65
    v_fmac_f32 v69, v19, v65
    v_fmac_f32 v70, v20, v65
    v_fmac_f32 v71, v21, v65
    v_fmac_f32 v72, v22, v65
    v_fmac_f32 v73, v23, v65
    v_fmac_f32 v74, v24, v65
    v_fmac_f32 v75, v25, v65
    v_fmac_f32 v68, v17, v66
    v_fmac_f32 v69, v18, v66
    v_fmac_f32 v70, v19, v66
    v_fmac_f32 v71, v20, v66
    v_fmac_f32 v72, v21, v66
    v_fmac_f32 v73, v22, v66
    v_fmac_f32 v74, v23, v66
    v_fmac_f32 v75, v24, v66
    v_fmac_f32 v68, v16, v67
    v_fmac_f32 v69, v17, v67
    v_fmac_f32 v70, v18, v67
    v_fmac_f32 v71, v19, v67
    v_fmac_f32 v72, v20, v67
    v_fmac_f32 v73, v21, v67
    v_fmac_f32 v74, v22, v67
    v_fmac_f32 v75, v23, v67
    v_mul_f32 v68, v68, v27
    v_mul_f32 v69, v69, v28
    v_mul_f32 v70, v70, v29
    v_mul_f32 v71, v71, v30
    v_mul_f32 v72, v72, v31
    v_mul_f32 v73, v73, v32
    v_mul_f32 v74, v74, v33
    v_mul_f32 v75, v75, v34
    v_cvt_pk_bf16_f32 v76, v75, v74
    v_cvt_pk_bf16_f32 v77, v73, v72
    v_cvt_pk_bf16_f32 v78, v71, v70
    v_cvt_pk_bf16_f32 v79, v69, v68
    s_mov_b32 s90, 0x100000
    buffer_store_dwordx4 v[76:79], v8, s[76:79], s90 offen sc1
    s_waitcnt vmcnt(4)
    s_and_b32 s92, s87, 15
    s_mov_b32 s90, 0x500000
    s_cmp_lt_u32 s92, 4
    s_cbranch_scc0 L_skip_3
    buffer_store_dwordx4 v[80:83], v9, s[76:79], s90 offen sc1
L_skip_3:
    s_mov_b32 s90, 0x300000
    buffer_store_dwordx4 v[80:83], v9, s[76:79], s90 offen sc1
    s_barrier
    v_readfirstlane_b32 s88, v126
    s_nop 0
    s_mul_i32 s88, s88, 1664525
    s_add_u32 s88, s88, 1013904223
    s_min_u32 s88, s88, -2
    v_mov_b32 v126, s88
    s_cmp_lt_u32 s86, 24
    s_cbranch_scc0 L_skip_4
    buffer_load_dwordx4 v[56:59], v12, s[68:71], 0 offen nt
    buffer_load_dwordx4 v[96:99], v13, s[36:39], 0 offen nt
L_skip_4:
    s_cmp_ge_u32 s86, 24
    s_cbranch_scc0 L_skip_5
    buffer_load_dwordx4 v[96:99], v13, s[36:39], 0 offen nt
L_skip_5:
    v_alignbit_b32 v16, v43, v42, 16
    v_alignbit_b32 v17, v44, v43, 16
    v_alignbit_b32 v18, v45, v44, 16
    v_alignbit_b32 v19, v46, v45, 16
    v_alignbit_b32 v20, v44, v43, 16
    v_alignbit_b32 v21, v45, v44, 16
    v_alignbit_b32 v22, v46, v45, 16
    v_alignbit_b32 v23, v47, v46, 16
    v_mov_b32 v24, v43
    v_mov_b32 v25, v44
    v_mov_b32 v26, v45
    v_mov_b32 v27, v46
    v_and_b32 v2, 255, v0
    v_lshlrev_b32 v2, 4, v2
    v_lshrrev_b32 v3, 8, v0
    v_mul_u32_u24 v3, 16640, v3
    v_add_u32 v2, v2, v3
    ds_write_b128 v2, v[16:19] offset:32
    ds_write_b128 v2, v[24:27] offset:4192
    ds_write_b128 v2, v[20:23] offset:8352
    ds_write_b128 v2, v[44:47] offset:12512
    s_cmp_lt_u32 s86, 24
    s_cbranch_scc0 L_skip_6
    s_waitcnt vmcnt(2)
L_skip_6:
    s_cmp_ge_u32 s86, 24
    s_cbranch_scc0 L_skip_7
    s_waitcnt vmcnt(1)
L_skip_7:
    s_waitcnt lgkmcnt(0)
    s_barrier
    s_cmp_eq_u32 s84, 0
    s_cbranch_scc0 L_skip_8
    s_lshl_b32 s91, s87, 1
    s_lshl_b32 s90, s91, 7
    s_add_u32 s90, s90, 0x10000
    v_mov_b32 v2, s88
    v_lshlrev_b32 v3, 2, v1
    s_mov_b32 exec_lo, 0xffff
    s_mov_b32 exec_hi, 0
    buffer_store_dword v2, v3, s[76:79], s90 offen sc1
    s_mov_b64 exec, -1
L_skip_8:
    s_cmp_eq_u32 s84, 0
    s_cbranch_scc0 L_skip_9
    v_and_b32 v2, 7, v1
    v_lshlrev_b32 v2, 4, v2
    v_lshrrev_b32 v3, 3, v1
    v_lshl_add_u32 v3, v3, 15, v2
    s_add_u32 s90, s6, 0xe0000
    s_mov_b32 exec_hi, 0
    buffer_store_dwordx4 v[80:83], v3, s[76:79], s90 offen sc1
    s_add_u32 s90, s5, 0x30000
    s_mov_b32 exec_lo, 0xff
    buffer_store_dwordx4 v[80:83], v2, s[76:79], s90 offen sc1
    s_mov_b64 exec, -1
L_skip_9:
    s_cmp_lt_u32 s84, 4
    s_cbranch_scc0 L_skip_10
    v_and_b32 v2, 15, v1
    v_lshrrev_b32 v3, 4, v1
    v_and_b32 v4, 3, v2
    v_mul_u32_u24 v4, 4160, v4
    v_lshrrev_b32 v2, 2, v2
    v_lshl_add_u32 v2, v3, 1, v2
    v_lshl_add_u32 v4, v2, 3, v4
    s_mul_i32 s92, s3, 16640
    s_lshl_b32 s91, s99, 8
    s_add_u32 s92, s92, s91
    v_add_u32 v4, s92, v4
    ds_read_b64 a[0:1], v4 offset:8
    ds_read_b64 a[2:3], v4 offset:16
    ds_read_b64 a[4:5], v4 offset:520
    ds_read_b64 a[6:7], v4 offset:528
    ds_read_b64 a[8:9], v4 offset:1032
    ds_read_b64 a[10:11], v4 offset:1040
    ds_read_b64 a[12:13], v4 offset:1544
    ds_read_b64 a[14:15], v4 offset:1552
    ds_read_b64 a[16:17], v4 offset:2056
    ds_read_b64 a[18:19], v4 offset:2064
    ds_read_b64 a[20:21], v4 offset:2568
    ds_read_b64 a[22:23], v4 offset:2576
    ds_read_b64 a[24:25], v4 offset:3080
    ds_read_b64 a[26:27], v4 offset:3088
    ds_read_b64 a[28:29], v4 offset:3592
    ds_read_b64 a[30:31], v4 offset:3600
    ds_read_b64 a[32:33], v4 offset:72
    ds_read_b64 a[34:35], v4 offset:80
    ds_read_b64 a[36:37], v4 offset:584
    ds_read_b64 a[38:39], v4 offset:592
    ds_read_b64 a[40:41], v4 offset:1096
    ds_read_b64 a[42:43], v4 offset:1104
    ds_read_b64 a[44:45], v4 offset:1608
    ds_read_b64 a[46:47], v4 offset:1616
    ds_read_b64 a[48:49], v4 offset:2120
    ds_read_b64 a[50:51], v4 offset:2128
    ds_read_b64 a[52:53], v4 offset:2632
    ds_read_b64 a[54:55], v4 offset:2640
    ds_read_b64 a[56:57], v4 offset:3144
    ds_read_b64 a[58:59], v4 offset:3152
    ds_read_b64 a[60:61], v4 offset:3656
    ds_read_b64 a[62:63], v4 offset:3664
    ds_read_b64 a[64:65], v4 offset:136
    ds_read_b64 a[66:67], v4 offset:144
    ds_read_b64 a[68:69], v4 offset:648
    ds_read_b64 a[70:71], v4 offset:656
    ds_read_b64 a[72:73], v4 offset:1160
    ds_read_b64 a[74:75], v4 offset:1168
    ds_read_b64 a[76:77], v4 offset:1672
    ds_read_b64 a[78:79], v4 offset:1680
    ds_read_b64 a[80:81], v4 offset:2184
    ds_read_b64 a[82:83], v4 offset:2192
    ds_read_b64 a[84:85], v4 offset:2696
    ds_read_b64 a[86:87], v4 offset:2704
    ds_read_b64 a[88:89], v4 offset:3208
    ds_read_b64 a[90:91], v4 offset:3216
    ds_read_b64 a[92:93], v4 offset:3720
    ds_read_b64 a[94:95], v4 offset:3728
    ds_read_b64 a[96:97], v4 offset:200
    ds_read_b64 a[98:99], v4 offset:208
    ds_read_b64 a[100:101], v4 offset:712
    ds_read_b64 a[102:103], v4 offset:720
    ds_read_b64 a[104:105], v4 offset:1224
    ds_read_b64 a[106:107], v4 offset:1232
    ds_read_b64 a[108:109], v4 offset:1736
    ds_read_b64 a[110:111], v4 offset:1744
    ds_read_b64 a[112:113], v4 offset:2248
    ds_read_b64 a[114:115], v4 offset:2256
    ds_read_b64 a[116:117], v4 offset:2760
    ds_read_b64 a[118:119], v4 offset:2768
    ds_read_b64 a[120:121], v4 offset:3272
    ds_read_b64 a[122:123], v4 offset:3280
    ds_read_b64 a[124:125], v4 offset:3784
    ds_read_b64 a[126:127], v4 offset:3792
L_skip_10:
    s_lshl_b32 s90, s87, 2
    s_load_dword s89, s[14:15], s90
    v_min_u32 v4, 31, v1
    v_lshlrev_b32 v4, 8, v4
    s_lshl_b32 s91, s85, 13
    s_add_u32 s91, s91, 0x10000
    s_waitcnt vmcnt(0)
    s_cmp_eq_u32 s84, 0
    s_cbranch_scc0 L_skip_11
    buffer_load_dword v125, v4, s[76:79], s91 offen sc1
L_skip_11:
    s_cmp_lt_u32 s86, 24
    s_cbranch_scc0 L_nomod_12
    v_mul_f32 v62, -1.4426950408889634, v60
    v_mul_f32 v63, -1.4426950408889634, v61
    v_exp_f32 v62, v62
    v_exp_f32 v63, v63
    v_add_f32 v62, 1.0, v62
    v_add_f32 v63, 1.0, v63
    v_rcp_f32 v62, v62
    v_rcp_f32 v63, v63
    v_mul_f32 v60, v60, v62
    v_mul_f32 v61, v61, v63
    v_cvt_pk_bf16_f32 v62, v60, v61
    v_and_b32 v61, 0xffff0000, v62
    v_lshlrev_b32 v60, 16, v62
    v_and_b32 v65, 0xffff0000, v52
    v_lshlrev_b32 v64, 16, v52
    v_and_b32 v67, 0xffff0000, v53
    v_lshlrev_b32 v66, 16, v53
    v_and_b32 v69, 0xffff0000, v54
    v_lshlrev_b32 v68, 16, v54
    v_and_b32 v71, 0xffff0000, v55
    v_lshlrev_b32 v70, 16, v55
    v_and_b32 v73, 0xffff0000, v56
    v_lshlrev_b32 v72, 16, v56
    v_and_b32 v75, 0xffff0000, v57
    v_lshlrev_b32 v74, 16, v57
    v_and_b32 v77, 0xffff0000, v58
    v_lshlrev_b32 v76, 16, v58
    v_and_b32 v79, 0xffff0000, v59
    v_lshlrev_b32 v78, 16, v59
    v_mul_f32 v64, v64, v60
    v_mul_f32 v65, v65, v60
    v_mul_f32 v66, v66, v60
    v_mul_f32 v67, v67, v60
    v_mul_f32 v68, v68, v60
    v_mul_f32 v69, v69, v60
    v_mul_f32 v70, v70, v60
    v_mul_f32 v71, v71, v60
    v_fmac_f32 v64, v72, v61
    v_fmac_f32 v65, v73, v61
    v_fmac_f32 v66, v74, v61
    v_fmac_f32 v67, v75, v61
    v_fmac_f32 v68, v76, v61
    v_fmac_f32 v69, v77, v61
    v_fmac_f32 v70, v78, v61
    v_fmac_f32 v71, v79, v61
    v_permlane32_swap_b32 v64, v68
    v_permlane32_swap_b32 v65, v69
    v_permlane32_swap_b32 v66, v70
    v_permlane32_swap_b32 v67, v71
    v_add_f32 v64, v64, v68
    v_add_f32 v65, v65, v69
    v_add_f32 v66, v66, v70
    v_add_f32 v67, v67, v71
    s_nop 0
    v_permlane16_swap_b32 v64, v66
    v_permlane16_swap_b32 v65, v67
    v_add_f32 v64, v64, v66
    v_add_f32 v65, v65, v67
    s_nop 0
    v_add_f32_dpp v64, v64, v64 row_ror:8 row_mask:0xf bank_mask:0xf
    v_add_f32_dpp v65, v65, v65 row_ror:8 row_mask:0xf bank_mask:0xf
    v_and_b32 v2, 7, v1
    v_lshlrev_b32 v2, 5, v2
    v_lshrrev_b32 v3, 4, v1
    v_lshl_add_u32 v2, v3, 3, v2
    s_lshl_b32 s90, s84, 8
    v_add_u32 v2, s90, v2
    ds_write_b64 v2, v[64:65] offset:42624
L_nomod_12:
    s_waitcnt lgkmcnt(0)
    v_lshrrev_b32 v6, 1, v0
    v_and_b32 v7, 1, v0
    v_lshl_add_u32 v8, s86, 3, v0
    v_and_b32 v8, 511, v8
    v_lshlrev_b32 v8, 4, v8
    v_xor_b32 v10, 4096, v8
    v_mul_u32_u24 v5, 4672, v7
    v_lshl_add_u32 v5, v6, 4, v5
    s_cmp_eq_u32 s84, 0
    s_cbranch_scc0 L_skip_14
    s_waitcnt vmcnt(0)
    v_cmp_ne_u32 vcc, s88, v125
    s_nop 4
    s_cbranch_vccnz L_retry_18
L_back_17:
L_skip_14:
    s_lshl_b32 s90, s87, 13
    s_add_u32 s90, s90, 0x100000
    s_barrier
    s_cmp_lt_u32 s84, 4
    s_cbranch_scc0 L_notconv_19
    buffer_load_dwordx4 v[16:19], v8, s[76:79], s90 offen sc1
    buffer_load_dwordx4 v[20:23], v10, s[76:79], s90 offen sc1
    s_barrier
    s_branch L_convgo_21
L_notconv_19:
    s_barrier
    s_cmp_eq_u32 s84, 6
    s_cbranch_scc0 L_skip_22
    s_cmp_eq_u32 s86, 28
    s_cbranch_scc0 L_skip_22
    s_lshl_b32 s90, s85, 7
    s_add_u32 s90, s90, 0x20000
    v_mov_b32 v2, s88
    v_lshlrev_b32 v3, 2, v1
    s_mov_b32 exec_lo, -1
    s_mov_b32 exec_hi, 0
    buffer_store_dword v2, v3, s[76:79], s90 offen sc1
    s_mov_b64 exec, -1
L_skip_22:
    s_cmp_eq_u32 s84, 4
    s_cbranch_scc0 L_skip_23
    s_cmp_lt_u32 s86, 24
    s_cbranch_scc0 L_skip_23
    v_lshlrev_b32 v4, 2, v1
    ds_read_b32 v64, v4 offset:42624
    ds_read_b32 v65, v4 offset:42880
    ds_read_b32 v66, v4 offset:43136
    ds_read_b32 v67, v4 offset:43392
    ds_read_b32 v68, v4 offset:43648
    ds_read_b32 v69, v4 offset:43904
    ds_read_b32 v70, v4 offset:44160
    ds_read_b32 v71, v4 offset:44416
    s_lshl_b32 s90, s34, 5
    s_add_u32 s90, s90, s35
    s_lshl_b32 s90, s90, 8
    s_add_u32 s90, s90, 0x40000
    s_waitcnt lgkmcnt(0)
    v_add_f32 v64, v64, v65
    v_add_f32 v64, v64, v66
    v_add_f32 v64, v64, v67
    v_add_f32 v64, v64, v68
    v_add_f32 v64, v64, v69
    v_add_f32 v64, v64, v70
    v_add_f32 v64, v64, v71
    v_min_u32 v64, -2, v64
    buffer_store_dword v64, v4, s[76:79], s90 offen sc1
L_skip_23:
    s_cmp_lt_u32 s86, 28
    s_cbranch_scc0 L_skip_24
    s_add_u32 s15, s4, 0
    s_and_b32 s15, s15, 7
    s_lshl_b32 s15, s15, 4
    s_and_b32 s33, s84, 3
    s_add_u32 s15, s15, s33
    s_mul_i32 s15, s15, 14336
    s_add_u32 s15, s15, s7
    s_lshl_b32 s33, s33, 11
    s_add_u32 m0, s33, 65536
    s_nop 0
    buffer_load_dwordx4 v120, s[56:59], s15 offen lds
    s_add_u32 m0, s33, 66560
    s_nop 0
    buffer_load_dwordx4 v121, s[60:63], s15 offen lds
    s_add_u32 s15, s15, 57344
    s_add_u32 m0, s33, 73728
    s_nop 0
    buffer_load_dwordx4 v120, s[56:59], s15 offen lds
    s_add_u32 m0, s33, 74752
    s_nop 0
    buffer_load_dwordx4 v121, s[60:63], s15 offen lds
L_skip_24:
    s_barrier
    s_cmp_lt_u32 s86, 28
    s_cbranch_scc0 L_skip_25
    s_add_u32 s15, s15, 57344
    s_add_u32 m0, s33, 81920
    s_nop 0
    buffer_load_dwordx4 v120, s[56:59], s15 offen lds
    s_add_u32 m0, s33, 82944
    s_nop 0
    buffer_load_dwordx4 v121, s[60:63], s15 offen lds
    s_add_u32 s15, s15, 57344
    s_add_u32 m0, s33, 90112
    s_nop 0
    buffer_load_dwordx4 v120, s[56:59], s15 offen lds
    s_add_u32 m0, s33, 91136
    s_nop 0
    buffer_load_dwordx4 v121, s[60:63], s15 offen lds
    s_add_u32 s15, s4, 1
    s_and_b32 s15, s15, 7
    s_lshl_b32 s15, s15, 4
    s_and_b32 s33, s84, 3
    s_add_u32 s15, s15, s33
    s_mul_i32 s15, s15, 14336
    s_add_u32 s15, s15, s7
    s_lshl_b32 s33, s33, 11
    s_add_u32 m0, s33, 98304
    s_nop 0
    buffer_load_dwordx4 v120, s[56:59], s15 offen lds
    s_add_u32 m0, s33, 99328
    s_nop 0
    buffer_load_dwordx4 v121, s[60:63], s15 offen lds
    s_add_u32 s15, s15, 57344
    s_add_u32 m0, s33, 106496
    s_nop 0
    buffer_load_dwordx4 v120, s[56:59], s15 offen lds
    s_add_u32 m0, s33, 107520
    s_nop 0
    buffer_load_dwordx4 v121, s[60:63], s15 offen lds
    s_add_u32 s15, s15, 57344
    s_add_u32 m0, s33, 114688
    s_nop 0
    buffer_load_dwordx4 v120, s[56:59], s15 offen lds
    s_add_u32 m0, s33, 115712
    s_nop 0
    buffer_load_dwordx4 v121, s[60:63], s15 offen lds
    s_add_u32 s15, s15, 57344
    s_add_u32 m0, s33, 122880
    s_nop 0
    buffer_load_dwordx4 v120, s[56:59], s15 offen lds
    s_add_u32 m0, s33, 123904
    s_nop 0
    buffer_load_dwordx4 v121, s[60:63], s15 offen lds
    s_add_u32 s15, s4, 2
    s_and_b32 s15, s15, 7
    s_lshl_b32 s15, s15, 4
    s_and_b32 s33, s84, 3
    s_add_u32 s15, s15, s33
    s_mul_i32 s15, s15, 14336
    s_add_u32 s15, s15, s7
    s_lshl_b32 s33, s33, 11
    s_add_u32 m0, s33, 131072
    s_nop 0
    buffer_load_dwordx4 v120, s[56:59], s15 offen lds
    s_add_u32 m0, s33, 132096
    s_nop 0
    buffer_load_dwordx4 v121, s[60:63], s15 offen lds
    s_add_u32 s15, s15, 57344
    s_add_u32 m0, s33, 139264
    s_nop 0
    buffer_load_dwordx4 v120, s[56:59], s15 offen lds
    s_add_u32 m0, s33, 140288
    s_nop 0
    buffer_load_dwordx4 v121, s[60:63], s15 offen lds
    s_add_u32 s15, s15, 57344
    s_add_u32 m0, s33, 147456
    s_nop 0
    buffer_load_dwordx4 v120, s[56:59], s15 offen lds
    s_add_u32 m0, s33, 148480
    s_nop 0
    buffer_load_dwordx4 v121, s[60:63], s15 offen lds
    s_add_u32 s15, s15, 57344
    s_add_u32 m0, s33, 155648
    s_nop 0
    buffer_load_dwordx4 v120, s[56:59], s15 offen lds
    s_add_u32 m0, s33, 156672
    s_nop 0
    buffer_load_dwordx4 v121, s[60:63], s15 offen lds
L_skip_25:
    s_cmp_ge_u32 s86, 28
    s_cbranch_scc0 L_skip_26
    s_cmp_lt_u32 s86, 31
    s_cbranch_scc0 L_skip_26
    s_mul_i32 s90, s85, 3
    s_add_u32 s90, s90, s86
    s_lshl_b32 s90, s90, 2
    s_add_u32 s90, s90, s84
    s_sub_u32 s90, s90, 116
    s_and_b32 s91, s90, 7
    s_lshr_b32 s90, s90, 3
    s_mul_i32 s91, s91, 229376
    s_mul_i32 s90, s90, 19456
    s_add_u32 s90, s90, s91
    v_lshlrev_b32 v4, 4, v1
    buffer_load_dwordx4 v[100:103], v4, s[64:67], s90 offen offset:0
    buffer_load_dwordx4 v[100:103], v4, s[64:67], s90 offen offset:1024
    buffer_load_dwordx4 v[100:103], v4, s[64:67], s90 offen offset:2048
    buffer_load_dwordx4 v[100:103], v4, s[64:67], s90 offen offset:3072
    s_add_u32 s90, s90, 4096
    buffer_load_dwordx4 v[100:103], v4, s[64:67], s90 offen offset:0
    buffer_load_dwordx4 v[100:103], v4, s[64:67], s90 offen offset:1024
    buffer_load_dwordx4 v[100:103], v4, s[64:67], s90 offen offset:2048
    buffer_load_dwordx4 v[100:103], v4, s[64:67], s90 offen offset:3072
    s_add_u32 s90, s90, 4096
    buffer_load_dwordx4 v[100:103], v4, s[64:67], s90 offen offset:0
    buffer_load_dwordx4 v[100:103], v4, s[64:67], s90 offen offset:1024
    buffer_load_dwordx4 v[100:103], v4, s[64:67], s90 offen offset:2048
    buffer_load_dwordx4 v[100:103], v4, s[64:67], s90 offen offset:3072
    s_add_u32 s90, s90, 4096
    buffer_load_dwordx4 v[100:103], v4, s[64:67], s90 offen offset:0
    buffer_load_dwordx4 v[100:103], v4, s[64:67], s90 offen offset:1024
    buffer_load_dwordx4 v[100:103], v4, s[64:67], s90 offen offset:2048
    buffer_load_dwordx4 v[100:103], v4, s[64:67], s90 offen offset:3072
    s_add_u32 s90, s90, 4096
    buffer_load_dwordx4 v[100:103], v4, s[64:67], s90 offen offset:0
    buffer_load_dwordx4 v[100:103], v4, s[64:67], s90 offen offset:1024
    buffer_load_dwordx4 v[100:103], v4, s[64:67], s90 offen offset:2048
L_skip_26:
    s_cmp_eq_u32 s84, 7
    s_cbranch_scc0 L_skip_27
    s_cmp_eq_u32 s86, 31
    s_cbranch_scc0 L_skip_27
    v_lshlrev_b32 v4, 2, v1
    s_lshl_b32 s90, s85, 13
    s_add_u32 s90, s90, 0x40000
    s_add_u32 s92, s90, 4096
    buffer_load_dword v8, v4, s[76:79], s90 offen offset:0 sc1
    buffer_load_dword v9, v4, s[76:79], s90 offen offset:256 sc1
    buffer_load_dword v10, v4, s[76:79], s90 offen offset:512 sc1
    buffer_load_dword v11, v4, s[76:79], s90 offen offset:768 sc1
    buffer_load_dword v12, v4, s[76:79], s90 offen offset:1024 sc1
    buffer_load_dword v13, v4, s[76:79], s90 offen offset:1280 sc1
    buffer_load_dword v14, v4, s[76:79], s90 offen offset:1536 sc1
    buffer_load_dword v15, v4, s[76:79], s90 offen offset:1792 sc1
    buffer_load_dword v16, v4, s[76:79], s90 offen offset:2048 sc1
    buffer_load_dword v17, v4, s[76:79], s90 offen offset:2304 sc1
    buffer_load_dword v18, v4, s[76:79], s90 offen offset:2560 sc1
    buffer_load_dword v19, v4, s[76:79], s90 offen offset:2816 sc1
    buffer_load_dword v20, v4, s[76:79], s90 offen offset:3072 sc1
    buffer_load_dword v21, v4, s[76:79], s90 offen offset:3328 sc1
    buffer_load_dword v22, v4, s[76:79], s90 offen offset:3584 sc1
    buffer_load_dword v23, v4, s[76:79], s90 offen offset:3840 sc1
    buffer_load_dword v24, v4, s[76:79], s92 offen offset:0 sc1
    buffer_load_dword v25, v4, s[76:79], s92 offen offset:256 sc1
    buffer_load_dword v26, v4, s[76:79], s92 offen offset:512 sc1
    buffer_load_dword v27, v4, s[76:79], s92 offen offset:768 sc1
    buffer_load_dword v28, v4, s[76:79], s92 offen offset:1024 sc1
    buffer_load_dword v29, v4, s[76:79], s92 offen offset:1280 sc1
    buffer_load_dword v30, v4, s[76:79], s92 offen offset:1536 sc1
    buffer_load_dword v31, v4, s[76:79], s92 offen offset:1792 sc1
    s_waitcnt vmcnt(0)
    v_max_u32 v125, v8, v9
    v_max3_u32 v125, v125, v10, v11
    v_max3_u32 v125, v125, v12, v13
    v_max3_u32 v125, v125, v14, v15
    v_max3_u32 v125, v125, v16, v17
    v_max3_u32 v125, v125, v18, v19
    v_max3_u32 v125, v125, v20, v21
    v_max3_u32 v125, v125, v22, v23
    v_max3_u32 v125, v125, v24, v25
    v_max3_u32 v125, v125, v26, v27
    v_max3_u32 v125, v125, v28, v29
    v_max3_u32 v125, v125, v30, v31
    v_cmp_eq_u32 vcc, -1, v125
    s_nop 4
    s_cbranch_vccz L_back_30
    s_mov_b32 s94, 0x8000
L_again_28:
    s_mov_b64 exec, vcc
    buffer_load_dword v8, v4, s[76:79], s90 offen offset:0 sc1
    buffer_load_dword v9, v4, s[76:79], s90 offen offset:256 sc1
    buffer_load_dword v10, v4, s[76:79], s90 offen offset:512 sc1
    buffer_load_dword v11, v4, s[76:79], s90 offen offset:768 sc1
    buffer_load_dword v12, v4, s[76:79], s90 offen offset:1024 sc1
    buffer_load_dword v13, v4, s[76:79], s90 offen offset:1280 sc1
    buffer_load_dword v14, v4, s[76:79], s90 offen offset:1536 sc1
    buffer_load_dword v15, v4, s[76:79], s90 offen offset:1792 sc1
    buffer_load_dword v16, v4, s[76:79], s90 offen offset:2048 sc1
    buffer_load_dword v17, v4, s[76:79], s90 offen offset:2304 sc1
    buffer_load_dword v18, v4, s[76:79], s90 offen offset:2560 sc1
    buffer_load_dword v19, v4, s[76:79], s90 offen offset:2816 sc1
    buffer_load_dword v20, v4, s[76:79], s90 offen offset:3072 sc1
    buffer_load_dword v21, v4, s[76:79], s90 offen offset:3328 sc1
    buffer_load_dword v22, v4, s[76:79], s90 offen offset:3584 sc1
    buffer_load_dword v23, v4, s[76:79], s90 offen offset:3840 sc1
    buffer_load_dword v24, v4, s[76:79], s92 offen offset:0 sc1
    buffer_load_dword v25, v4, s[76:79], s92 offen offset:256 sc1
    buffer_load_dword v26, v4, s[76:79], s92 offen offset:512 sc1
    buffer_load_dword v27, v4, s[76:79], s92 offen offset:768 sc1
    buffer_load_dword v28, v4, s[76:79], s92 offen offset:1024 sc1
    buffer_load_dword v29, v4, s[76:79], s92 offen offset:1280 sc1
    buffer_load_dword v30, v4, s[76:79], s92 offen offset:1536 sc1
    buffer_load_dword v31, v4, s[76:79], s92 offen offset:1792 sc1
    s_waitcnt vmcnt(0)
    v_max_u32 v125, v8, v9
    v_max3_u32 v125, v125, v10, v11
    v_max3_u32 v125, v125, v12, v13
    v_max3_u32 v125, v125, v14, v15
    v_max3_u32 v125, v125, v16, v17
    v_max3_u32 v125, v125, v18, v19
    v_max3_u32 v125, v125, v20, v21
    v_max3_u32 v125, v125, v22, v23
    v_max3_u32 v125, v125, v24, v25
    v_max3_u32 v125, v125, v26, v27
    v_max3_u32 v125, v125, v28, v29
    v_max3_u32 v125, v125, v30, v31
    v_cmp_eq_u32 vcc, -1, v125
    s_nop 4
    s_cbranch_vccz L_arrived_29
    s_sub_u32 s94, s94, 1
    s_cmp_lg_u32 s94, 0
    s_cbranch_scc1 L_again_28
L_arrived_29:
    s_mov_b64 exec, -1
L_back_30:
    s_lshl_b32 s91, s85, 8
    v_add_f32 v8, v8, v9
    v_add_f32 v10, v10, v11
    v_add_f32 v8, v8, v10
    v_cvt_pk_bf16_f32 v8, v8, v8
    v_lshlrev_b32 v8, 16, v8
    v_add_f32 v12, v12, v13
    v_add_f32 v14, v14, v15
    v_add_f32 v12, v12, v14
    v_cvt_pk_bf16_f32 v12, v12, v12
    v_lshlrev_b32 v12, 16, v12
    v_add_f32 v12, 1.0, v12
    v_cvt_pk_bf16_f32 v12, v12, v12
    v_lshlrev_b32 v12, 16, v12
    v_add_f32 v16, v16, v17
    v_add_f32 v18, v18, v19
    v_add_f32 v16, v16, v18
    v_cvt_pk_bf16_f32 v16, v16, v16
    v_lshlrev_b32 v16, 16, v16
    v_add_f32 v20, v20, v21
    v_add_f32 v22, v22, v23
    v_add_f32 v20, v20, v22
    v_cvt_pk_bf16_f32 v20, v20, v20
    v_lshlrev_b32 v20, 16, v20
    v_add_f32 v24, v24, v25
    v_add_f32 v26, v26, v27
    v_add_f32 v24, v24, v26
    v_cvt_pk_bf16_f32 v24, v24, v24
    v_lshlrev_b32 v24, 16, v24
    v_add_f32 v24, 1.0, v24
    v_cvt_pk_bf16_f32 v24, v24, v24
    v_lshlrev_b32 v24, 16, v24
    v_add_f32 v28, v28, v29
    v_add_f32 v30, v30, v31
    v_add_f32 v28, v28, v30
    v_cvt_pk_bf16_f32 v28, v28, v28
    v_lshlrev_b32 v28, 16, v28
    v_mul_f32 v12, v12, v16
    v_mul_f32 v8, v8, v16
    v_min_u32 v12, -2, v12
    s_add_u32 s90, s91, 0x50000
    buffer_store_dword v12, v4, s[76:79], s90 offen sc1
    v_min_u32 v8, -2, v8
    s_add_u32 s90, s91, 0x50800
    buffer_store_dword v8, v4, s[76:79], s90 offen sc1
    v_min_u32 v24, -2, v24
    s_add_u32 s90, s91, 0x51000
    buffer_store_dword v24, v4, s[76:79], s90 offen sc1
    v_min_u32 v20, -2, v20
    s_add_u32 s90, s91, 0x51800
    buffer_store_dword v20, v4, s[76:79], s90 offen sc1
    v_min_u32 v28, -2, v28
    s_add_u32 s90, s91, 0x52000
    buffer_store_dword v28, v4, s[76:79], s90 offen sc1
L_skip_27:
    v_lshrrev_b32 v2, 2, v1
    v_and_b32 v3, 3, v1
    v_mul_u32_u24 v3, 320, v3
    v_lshl_add_u32 v2, v2, 4, v3
    s_mul_i32 s90, s3, 1280
    s_lshl_b32 s91, s99, 3
    s_add_u32 s90, s90, s91
    v_add_u32 v2, s90, v2
    v_xor_b32 v3, 1, v0
    v_and_b32 v4, 0, v0
    v_add_lshl_u32 v3, v3, v4, 3
    s_lshl_b32 s90, s89, 16
    s_and_b32 s91, s89, 0xffff0000
    s_lshl_b32 s92, s87, 13
    s_add_u32 s92, s92, 0x300000
    v_lshl_add_u32 v4, s87, 3, v0
    v_and_b32 v4, 511, v4
    v_lshlrev_b32 v4, 4, v4
    v_min_u32 v123, 7, v1
    v_lshlrev_b32 v123, 7, v123
    s_mov_b32 s93, 0x20000
    s_branch L_convj_20
L_convgo_21:
    v_and_b32 v2, 15, v1
    v_lshrrev_b32 v3, 4, v1
    s_lshl_b32 s91, s99, 8
    v_lshlrev_b32 v6, 1, v2
    v_sub_u32 v6, v6, v3
    v_lshlrev_b32 v6, 4, v6
    s_mul_i32 s92, s3, 4672
    s_add_u32 s92, s92, 33616
    s_sub_u32 s92, s92, s91
    v_add_u32 v6, s92, v6
    v_mul_u32_u24 v3, 320, v3
    v_lshl_add_u32 v7, v2, 4, v3
    s_mul_i32 s90, s84, 5120
    v_add_u32 v7, s90, v7
    s_waitcnt vmcnt(0)
    ds_write_b128 v5, v[16:19] offset:33792
    ds_write_b128 v5, v[20:23] offset:35840
    s_waitcnt lgkmcnt(0)
    s_barrier
    ds_read_b128 v[40:43], v6 offset:192
    ds_read_b128 v[44:47], v6 offset:704
    ds_read_b128 v[48:51], v6 offset:1216
    ds_read_b128 v[52:55], v6 offset:1728
    s_waitcnt lgkmcnt(3)
    v_mfma_f32_16x16x32_bf16 v[8:11], a[0:3], v[40:43], 0
    ds_read_b128 v[56:59], v6 offset:2240
    v_mfma_f32_16x16x32_bf16 v[12:15], a[4:7], v[40:43], 0
    ds_read_b128 v[60:63], v6 offset:2752
    v_mfma_f32_16x16x32_bf16 v[16:19], a[8:11], v[40:43], 0
    ds_read_b128 v[64:67], v6 offset:3264
    v_mfma_f32_16x16x32_bf16 v[20:23], a[12:15], v[40:43], 0
    ds_read_b128 v[68:71], v6 offset:3776
    v_mfma_f32_16x16x32_bf16 v[24:27], a[16:19], v[40:43], 0
    ds_read_b128 v[72:75], v6 offset:128
    v_mfma_f32_16x16x32_bf16 v[28:31], a[20:23], v[40:43], 0
    ds_read_b128 v[76:79], v6 offset:640
    v_mfma_f32_16x16x32_bf16 v[32:35], a[24:27], v[40:43], 0
    ds_read_b128 v[80:83], v6 offset:1152
    v_mfma_f32_16x16x32_bf16 v[36:39], a[28:31], v[40:43], 0
    ds_read_b128 v[84:87], v6 offset:1664
    s_waitcnt lgkmcnt(8)
    v_mfma_f32_16x16x32_bf16 v[12:15], a[0:3], v[44:47], v[12:15]
    ds_read_b128 v[92:95], v6 offset:2176
    v_mfma_f32_16x16x32_bf16 v[16:19], a[4:7], v[44:47], v[16:19]
    ds_read_b128 v[100:103], v6 offset:2688
    v_mfma_f32_16x16x32_bf16 v[20:23], a[8:11], v[44:47], v[20:23]
    ds_read_b128 v[104:107], v6 offset:3200
    v_mfma_f32_16x16x32_bf16 v[24:27], a[12:15], v[44:47], v[24:27]
    ds_read_b128 v[108:111], v6 offset:3712
    s_waitcnt lgkmcnt(8)
    v_mfma_f32_16x16x32_bf16 v[28:31], a[16:19], v[44:47], v[28:31]
    ds_read_b128 v[112:115], v6 offset:64
    v_mfma_f32_16x16x32_bf16 v[32:35], a[20:23], v[44:47], v[32:35]
    ds_read_b128 v[116:119], v6 offset:576
    v_mfma_f32_16x16x32_bf16 v[36:39], a[24:27], v[44:47], v[36:39]
    ds_read_b128 v[40:43], v6 offset:1088
    v_mfma_f32_16x16x32_bf16 v[16:19], a[0:3], v[48:51], v[16:19]
    ds_read_b128 v[44:47], v6 offset:1600
    s_waitcnt lgkmcnt(8)
    v_mfma_f32_16x16x32_bf16 v[20:23], a[4:7], v[48:51], v[20:23]
    v_mfma_f32_16x16x32_bf16 v[24:27], a[8:11], v[48:51], v[24:27]
    v_mfma_f32_16x16x32_bf16 v[28:31], a[12:15], v[48:51], v[28:31]
    v_mfma_f32_16x16x32_bf16 v[32:35], a[16:19], v[48:51], v[32:35]
    v_mfma_f32_16x16x32_bf16 v[36:39], a[20:23], v[48:51], v[36:39]
    ds_read_b128 v[48:51], v6 offset:2112
    v_mfma_f32_16x16x32_bf16 v[20:23], a[0:3], v[52:55], v[20:23]
    v_mfma_f32_16x16x32_bf16 v[24:27], a[4:7], v[52:55], v[24:27]
    v_mfma_f32_16x16x32_bf16 v[28:31], a[8:11], v[52:55], v[28:31]
    v_mfma_f32_16x16x32_bf16 v[32:35], a[12:15], v[52:55], v[32:35]
    v_mfma_f32_16x16x32_bf16 v[36:39], a[16:19], v[52:55], v[36:39]
    ds_read_b128 v[52:55], v6 offset:2624
    v_mfma_f32_16x16x32_bf16 v[24:27], a[0:3], v[56:59], v[24:27]
    v_mfma_f32_16x16x32_bf16 v[28:31], a[4:7], v[56:59], v[28:31]
    v_mfma_f32_16x16x32_bf16 v[32:35], a[8:11], v[56:59], v[32:35]
    v_mfma_f32_16x16x32_bf16 v[36:39], a[12:15], v[56:59], v[36:39]
    ds_read_b128 v[56:59], v6 offset:3136
    v_mfma_f32_16x16x32_bf16 v[28:31], a[0:3], v[60:63], v[28:31]
    v_mfma_f32_16x16x32_bf16 v[32:35], a[4:7], v[60:63], v[32:35]
    v_mfma_f32_16x16x32_bf16 v[36:39], a[8:11], v[60:63], v[36:39]
    ds_read_b128 v[60:63], v6 offset:3648
    s_waitcnt lgkmcnt(3)
    v_mfma_f32_16x16x32_bf16 v[32:35], a[0:3], v[64:67], v[32:35]
    v_mfma_f32_16x16x32_bf16 v[36:39], a[4:7], v[64:67], v[36:39]
    ds_read_b128 v[64:67], v6 offset:0
    v_mfma_f32_16x16x32_bf16 v[36:39], a[0:3], v[68:71], v[36:39]
    ds_read_b128 v[68:71], v6 offset:512
    v_mfma_f32_16x16x32_bf16 v[8:11], a[32:35], v[72:75], v[8:11]
    v_mfma_f32_16x16x32_bf16 v[12:15], a[36:39], v[72:75], v[12:15]
    v_mfma_f32_16x16x32_bf16 v[16:19], a[40:43], v[72:75], v[16:19]
    v_mfma_f32_16x16x32_bf16 v[20:23], a[44:47], v[72:75], v[20:23]
    v_mfma_f32_16x16x32_bf16 v[24:27], a[48:51], v[72:75], v[24:27]
    v_lshrrev_b32 v2, 2, v1
    v_mfma_f32_16x16x32_bf16 v[28:31], a[52:55], v[72:75], v[28:31]
    v_and_b32 v3, 3, v1
    v_mfma_f32_16x16x32_bf16 v[32:35], a[56:59], v[72:75], v[32:35]
    v_mul_u32_u24 v3, 320, v3
    v_mfma_f32_16x16x32_bf16 v[36:39], a[60:63], v[72:75], v[36:39]
    v_lshl_add_u32 v2, v2, 4, v3
    ds_read_b128 v[72:75], v6 offset:1024
    v_mfma_f32_16x16x32_bf16 v[12:15], a[32:35], v[76:79], v[12:15]
    s_mul_i32 s90, s3, 1280
    v_mfma_f32_16x16x32_bf16 v[16:19], a[36:39], v[76:79], v[16:19]
    s_lshl_b32 s91, s99, 3
    v_mfma_f32_16x16x32_bf16 v[20:23], a[40:43], v[76:79], v[20:23]
    s_add_u32 s90, s90, s91
    v_mfma_f32_16x16x32_bf16 v[24:27], a[44:47], v[76:79], v[24:27]
    v_add_u32 v2, s90, v2
    v_mfma_f32_16x16x32_bf16 v[28:31], a[48:51], v[76:79], v[28:31]
    v_xor_b32 v3, 1, v0
    v_mfma_f32_16x16x32_bf16 v[32:35], a[52:55], v[76:79], v[32:35]
    v_and_b32 v4, 0, v0
    v_mfma_f32_16x16x32_bf16 v[36:39], a[56:59], v[76:79], v[36:39]
    v_add_lshl_u32 v3, v3, v4, 3
    ds_read_b128 v[76:79], v6 offset:1536
    v_mfma_f32_16x16x32_bf16 v[16:19], a[32:35], v[80:83], v[16:19]
    s_lshl_b32 s90, s89, 16
    v_mfma_f32_16x16x32_bf16 v[20:23], a[36:39], v[80:83], v[20:23]
    s_and_b32 s91, s89, 0xffff0000
    v_mfma_f32_16x16x32_bf16 v[24:27], a[40:43], v[80:83], v[24:27]
    s_lshl_b32 s92, s87, 13
    v_mfma_f32_16x16x32_bf16 v[28:31], a[44:47], v[80:83], v[28:31]
    s_add_u32 s92, s92, 0x300000
    v_mfma_f32_16x16x32_bf16 v[32:35], a[48:51], v[80:83], v[32:35]
    v_lshl_add_u32 v4, s87, 3, v0
    v_mfma_f32_16x16x32_bf16 v[36:39], a[52:55], v[80:83], v[36:39]
    v_and_b32 v4, 511, v4
    ds_read_b128 v[80:83], v6 offset:2048
    v_mfma_f32_16x16x32_bf16 v[20:23], a[32:35], v[84:87], v[20:23]
    v_lshlrev_b32 v4, 4, v4
    v_mfma_f32_16x16x32_bf16 v[24:27], a[36:39], v[84:87], v[24:27]
    v_min_u32 v123, 7, v1
    v_mfma_f32_16x16x32_bf16 v[28:31], a[40:43], v[84:87], v[28:31]
    v_lshlrev_b32 v123, 7, v123
    v_mfma_f32_16x16x32_bf16 v[32:35], a[44:47], v[84:87], v[32:35]
    s_mov_b32 s93, 0x20000
    v_mfma_f32_16x16x32_bf16 v[36:39], a[48:51], v[84:87], v[36:39]
    ds_read_b128 v[84:87], v6 offset:2560
    v_mfma_f32_16x16x32_bf16 v[24:27], a[32:35], v[92:95], v[24:27]
    v_mfma_f32_16x16x32_bf16 v[28:31], a[36:39], v[92:95], v[28:31]
    v_mfma_f32_16x16x32_bf16 v[32:35], a[40:43], v[92:95], v[32:35]
    v_mfma_f32_16x16x32_bf16 v[36:39], a[44:47], v[92:95], v[36:39]
    ds_read_b128 v[92:95], v6 offset:3072
    v_mfma_f32_16x16x32_bf16 v[28:31], a[32:35], v[100:103], v[28:31]
    v_mfma_f32_16x16x32_bf16 v[32:35], a[36:39], v[100:103], v[32:35]
    v_mfma_f32_16x16x32_bf16 v[36:39], a[40:43], v[100:103], v[36:39]
    ds_read_b128 v[100:103], v6 offset:3584
    v_mfma_f32_16x16x32_bf16 v[32:35], a[32:35], v[104:107], v[32:35]
    v_mfma_f32_16x16x32_bf16 v[36:39], a[36:39], v[104:107], v[36:39]
    v_mfma_f32_16x16x32_bf16 v[36:39], a[32:35], v[108:111], v[36:39]
    v_mfma_f32_16x16x32_bf16 v[8:11], a[64:67], v[112:115], v[8:11]
    v_mfma_f32_16x16x32_bf16 v[12:15], a[68:71], v[112:115], v[12:15]
    v_mfma_f32_16x16x32_bf16 v[16:19], a[72:75], v[112:115], v[16:19]
    v_mfma_f32_16x16x32_bf16 v[20:23], a[76:79], v[112:115], v[20:23]
    v_mfma_f32_16x16x32_bf16 v[24:27], a[80:83], v[112:115], v[24:27]
    v_mfma_f32_16x16x32_bf16 v[28:31], a[84:87], v[112:115], v[28:31]
    v_mfma_f32_16x16x32_bf16 v[32:35], a[88:91], v[112:115], v[32:35]
    v_mfma_f32_16x16x32_bf16 v[36:39], a[92:95], v[112:115], v[36:39]
    v_mfma_f32_16x16x32_bf16 v[12:15], a[64:67], v[116:119], v[12:15]
    v_mfma_f32_16x16x32_bf16 v[16:19], a[68:71], v[116:119], v[16:19]
    v_mfma_f32_16x16x32_bf16 v[20:23], a[72:75], v[116:119], v[20:23]
    v_mfma_f32_16x16x32_bf16 v[24:27], a[76:79], v[116:119], v[24:27]
    v_mfma_f32_16x16x32_bf16 v[28:31], a[80:83], v[116:119], v[28:31]
    v_mfma_f32_16x16x32_bf16 v[32:35], a[84:87], v[116:119], v[32:35]
    v_mfma_f32_16x16x32_bf16 v[36:39], a[88:91], v[116:119], v[36:39]
    v_mfma_f32_16x16x32_bf16 v[16:19], a[64:67], v[40:43], v[16:19]
    v_mfma_f32_16x16x32_bf16 v[20:23], a[68:71], v[40:43], v[20:23]
    v_mfma_f32_16x16x32_bf16 v[24:27], a[72:75], v[40:43], v[24:27]
    v_mfma_f32_16x16x32_bf16 v[28:31], a[76:79], v[40:43], v[28:31]
    v_mfma_f32_16x16x32_bf16 v[32:35], a[80:83], v[40:43], v[32:35]
    v_mfma_f32_16x16x32_bf16 v[36:39], a[84:87], v[40:43], v[36:39]
    v_mfma_f32_16x16x32_bf16 v[20:23], a[64:67], v[44:47], v[20:23]
    v_mfma_f32_16x16x32_bf16 v[24:27], a[68:71], v[44:47], v[24:27]
    v_mfma_f32_16x16x32_bf16 v[28:31], a[72:75], v[44:47], v[28:31]
    v_mfma_f32_16x16x32_bf16 v[32:35], a[76:79], v[44:47], v[32:35]
    v_mfma_f32_16x16x32_bf16 v[36:39], a[80:83], v[44:47], v[36:39]
    v_mfma_f32_16x16x32_bf16 v[24:27], a[64:67], v[48:51], v[24:27]
    v_mfma_f32_16x16x32_bf16 v[28:31], a[68:71], v[48:51], v[28:31]
    v_mfma_f32_16x16x32_bf16 v[32:35], a[72:75], v[48:51], v[32:35]
    v_mfma_f32_16x16x32_bf16 v[36:39], a[76:79], v[48:51], v[36:39]
    s_waitcnt lgkmcnt(0)
    v_mfma_f32_16x16x32_bf16 v[28:31], a[64:67], v[52:55], v[28:31]
    v_mfma_f32_16x16x32_bf16 v[32:35], a[68:71], v[52:55], v[32:35]
    v_mfma_f32_16x16x32_bf16 v[36:39], a[72:75], v[52:55], v[36:39]
    v_mfma_f32_16x16x32_bf16 v[32:35], a[64:67], v[56:59], v[32:35]
    v_mfma_f32_16x16x32_bf16 v[36:39], a[68:71], v[56:59], v[36:39]
    v_mfma_f32_16x16x32_bf16 v[36:39], a[64:67], v[60:63], v[36:39]
    v_mfma_f32_16x16x32_bf16 v[8:11], a[96:99], v[64:67], v[8:11]
    v_mfma_f32_16x16x32_bf16 v[12:15], a[100:103], v[64:67], v[12:15]
    v_mfma_f32_16x16x32_bf16 v[16:19], a[104:107], v[64:67], v[16:19]
    v_mfma_f32_16x16x32_bf16 v[20:23], a[108:111], v[64:67], v[20:23]
    v_mfma_f32_16x16x32_bf16 v[24:27], a[112:115], v[64:67], v[24:27]
    v_mfma_f32_16x16x32_bf16 v[28:31], a[116:119], v[64:67], v[28:31]
    v_mfma_f32_16x16x32_bf16 v[32:35], a[120:123], v[64:67], v[32:35]
    v_mfma_f32_16x16x32_bf16 v[36:39], a[124:127], v[64:67], v[36:39]
    v_mfma_f32_16x16x32_bf16 v[12:15], a[96:99], v[68:71], v[12:15]
    v_cvt_pk_bf16_f32 v8, v8, v9
    v_cvt_pk_bf16_f32 v9, v10, v11
    v_mfma_f32_16x16x32_bf16 v[16:19], a[100:103], v[68:71], v[16:19]
    v_mfma_f32_16x16x32_bf16 v[20:23], a[104:107], v[68:71], v[20:23]
    v_mfma_f32_16x16x32_bf16 v[24:27], a[108:111], v[68:71], v[24:27]
    v_mfma_f32_16x16x32_bf16 v[28:31], a[112:115], v[68:71], v[28:31]
    v_mfma_f32_16x16x32_bf16 v[32:35], a[116:119], v[68:71], v[32:35]
    v_mfma_f32_16x16x32_bf16 v[36:39], a[120:123], v[68:71], v[36:39]
    v_mfma_f32_16x16x32_bf16 v[16:19], a[96:99], v[72:75], v[16:19]
    v_mfma_f32_16x16x32_bf16 v[20:23], a[100:103], v[72:75], v[20:23]
    v_cvt_pk_bf16_f32 v10, v12, v13
    v_cvt_pk_bf16_f32 v11, v14, v15
    v_mfma_f32_16x16x32_bf16 v[24:27], a[104:107], v[72:75], v[24:27]
    v_mfma_f32_16x16x32_bf16 v[28:31], a[108:111], v[72:75], v[28:31]
    v_mfma_f32_16x16x32_bf16 v[32:35], a[112:115], v[72:75], v[32:35]
    v_mfma_f32_16x16x32_bf16 v[36:39], a[116:119], v[72:75], v[36:39]
    v_mfma_f32_16x16x32_bf16 v[20:23], a[96:99], v[76:79], v[20:23]
    v_mfma_f32_16x16x32_bf16 v[24:27], a[100:103], v[76:79], v[24:27]
    v_mfma_f32_16x16x32_bf16 v[28:31], a[104:107], v[76:79], v[28:31]
    v_cvt_pk_bf16_f32 v16, v16, v17
    v_cvt_pk_bf16_f32 v17, v18, v19
    v_mfma_f32_16x16x32_bf16 v[32:35], a[108:111], v[76:79], v[32:35]
    v_mfma_f32_16x16x32_bf16 v[36:39], a[112:115], v[76:79], v[36:39]
    v_mfma_f32_16x16x32_bf16 v[24:27], a[96:99], v[80:83], v[24:27]
    v_mfma_f32_16x16x32_bf16 v[28:31], a[100:103], v[80:83], v[28:31]
    v_mfma_f32_16x16x32_bf16 v[32:35], a[104:107], v[80:83], v[32:35]
    v_mfma_f32_16x16x32_bf16 v[36:39], a[108:111], v[80:83], v[36:39]
    v_cvt_pk_bf16_f32 v18, v20, v21
    v_cvt_pk_bf16_f32 v19, v22, v23
    v_mfma_f32_16x16x32_bf16 v[28:31], a[96:99], v[84:87], v[28:31]
    v_mfma_f32_16x16x32_bf16 v[32:35], a[100:103], v[84:87], v[32:35]
    v_mfma_f32_16x16x32_bf16 v[36:39], a[104:107], v[84:87], v[36:39]
    v_mfma_f32_16x16x32_bf16 v[32:35], a[96:99], v[92:95], v[32:35]
    v_mfma_f32_16x16x32_bf16 v[36:39], a[100:103], v[92:95], v[36:39]
    v_cvt_pk_bf16_f32 v24, v24, v25
    v_cvt_pk_bf16_f32 v25, v26, v27
    v_mfma_f32_16x16x32_bf16 v[36:39], a[96:99], v[100:103], v[36:39]
    ds_write_b128 v7, v[8:11] offset:0
    ds_write_b128 v7, v[16:19] offset:1280
    v_cvt_pk_bf16_f32 v26, v28, v29
    v_cvt_pk_bf16_f32 v27, v30, v31
    ds_write_b128 v7, v[24:27] offset:2560
    v_cvt_pk_bf16_f32 v32, v32, v33
    v_cvt_pk_bf16_f32 v33, v34, v35
    s_nop 0
    v_cvt_pk_bf16_f32 v34, v36, v37
    v_cvt_pk_bf16_f32 v35, v38, v39
    ds_write_b128 v7, v[32:35] offset:3840
L_convj_20:
    ds_read_b64 v[56:57], v3 offset:33792
    ds_read_b64 v[58:59], v3 offset:38464
    s_waitcnt lgkmcnt(0)
    s_barrier
    ds_read_b64 v[68:69], v2 offset:0
    ds_read_b64 v[70:71], v2 offset:5120
    ds_read_b64 v[72:73], v2 offset:10240
    ds_read_b64 v[74:75], v2 offset:15360
    v_and_b32 v61, 0xffff0000, v56
    v_lshlrev_b32 v60, 16, v56
    v_and_b32 v63, 0xffff0000, v57
    v_lshlrev_b32 v62, 16, v57
    v_and_b32 v65, 0xffff0000, v58
    v_lshlrev_b32 v64, 16, v58
    v_and_b32 v67, 0xffff0000, v59
    v_lshlrev_b32 v66, 16, v59
    s_waitcnt lgkmcnt(2)
    v_and_b32 v41, 0xffff0000, v68
    v_lshlrev_b32 v40, 16, v68
    v_and_b32 v43, 0xffff0000, v69
    v_lshlrev_b32 v42, 16, v69
    v_and_b32 v45, 0xffff0000, v70
    v_lshlrev_b32 v44, 16, v70
    v_and_b32 v47, 0xffff0000, v71
    v_lshlrev_b32 v46, 16, v71
    v_fmac_f32 v40, s90, v63
    v_fmac_f32 v41, s90, v62
    v_fmac_f32 v42, s90, v61
    v_fmac_f32 v43, s90, v60
    v_pk_add_f32 v[40:41], v[40:41], v[44:45]
    v_pk_add_f32 v[42:43], v[42:43], v[46:47]
    s_waitcnt lgkmcnt(0)
    v_and_b32 v49, 0xffff0000, v72
    v_lshlrev_b32 v48, 16, v72
    v_and_b32 v51, 0xffff0000, v73
    v_lshlrev_b32 v50, 16, v73
    v_and_b32 v53, 0xffff0000, v74
    v_lshlrev_b32 v52, 16, v74
    v_and_b32 v55, 0xffff0000, v75
    v_lshlrev_b32 v54, 16, v75
    v_fmac_f32 v48, s91, v67
    v_fmac_f32 v49, s91, v66
    v_fmac_f32 v50, s91, v65
    v_fmac_f32 v51, s91, v64
    v_pk_add_f32 v[48:49], v[48:49], v[52:53]
    v_pk_add_f32 v[50:51], v[50:51], v[54:55]
    v_cvt_pk_bf16_f32 v56, v40, v48
    v_cvt_pk_bf16_f32 v57, v41, v49
    v_cvt_pk_bf16_f32 v58, v42, v50
    v_cvt_pk_bf16_f32 v59, v43, v51
    v_min_u32 v56, -2, v56
    v_min_u32 v57, -2, v57
    v_min_u32 v58, -2, v58
    v_min_u32 v59, -2, v59
    s_cmp_eq_u32 s84, 4
    s_cbranch_scc0 L_skip_32
    buffer_load_dword v125, v123, s[76:79], s93 offen sc1
L_skip_32:
    buffer_store_dwordx4 v[56:59], v4, s[76:79], s92 offen sc1
    s_barrier
    s_add_u32 s15, s4, 3
    s_and_b32 s15, s15, 7
    s_lshl_b32 s15, s15, 4
    s_and_b32 s33, s84, 7
    s_add_u32 s15, s15, s33
    s_mul_i32 s15, s15, 14336
    s_add_u32 s15, s15, s7
    s_lshl_b32 s33, s33, 11
    s_add_u32 m0, s33, 0
    s_nop 0
    buffer_load_dwordx4 v120, s[56:59], s15 offen lds
    s_add_u32 m0, s33, 1024
    s_nop 0
    buffer_load_dwordx4 v121, s[60:63], s15 offen lds
    s_add_u32 s15, s15, 114688
    s_add_u32 m0, s33, 16384
    s_nop 0
    buffer_load_dwordx4 v120, s[56:59], s15 offen lds
    s_add_u32 m0, s33, 17408
    s_nop 0
    buffer_load_dwordx4 v121, s[60:63], s15 offen lds
    s_add_u32 s15, s4, 4
    s_and_b32 s15, s15, 7
    s_lshl_b32 s15, s15, 4
    s_and_b32 s33, s84, 7
    s_add_u32 s15, s15, s33
    s_mul_i32 s15, s15, 14336
    s_add_u32 s15, s15, s7
    s_lshl_b32 s33, s33, 11
    s_add_u32 m0, s33, 32768
    s_nop 0
    buffer_load_dwordx4 v120, s[56:59], s15 offen lds
    s_add_u32 m0, s33, 33792
    s_nop 0
    buffer_load_dwordx4 v121, s[60:63], s15 offen lds
    v_lshrrev_b32 v6, 1, v0
    v_and_b32 v7, 1, v0
    v_lshl_add_u32 v28, v6, 2, s87
    v_and_b32 v28, 255, v28
    v_lshl_add_u32 v28, v28, 1, v7
    v_lshlrev_b32 v28, 4, v28
    v_lshl_add_u32 v28, v6, 13, v28
    v_mul_u32_u24 v5, 4160, v7
    v_lshl_add_u32 v5, v6, 2, v5
    v_add_u32 v5, 98304, v5
    s_mul_i32 s90, s84, 1040
    s_add_u32 s90, s90, 98304
    v_lshl_add_u32 v6, v1, 4, s90
    v_lshlrev_b32 v7, 4, v1
    v_add_u32 v4, 106752, v7
    v_lshlrev_b32 v30, 4, v0
    v_bfe_u32 v31, v0, 1, 6
    v_lshlrev_b32 v31, 4, v31
    v_and_b32 v3, 1, v0
    v_mul_u32_u24 v3, 1088, v3
    s_mul_i32 s91, s3, 2176
    s_add_u32 s91, s91, 106752
    v_add3_u32 v31, v31, v3, s91
    s_mov_b32 s90, 0x300000
    s_mov_b32 s91, 0x50000
    s_cmp_eq_u32 s84, 4
    s_cbranch_scc0 L_skip_33
    s_waitcnt vmcnt(7)
    v_cmp_ne_u32 vcc, s88, v125
    s_nop 4
    s_cbranch_vccnz L_retry_37
L_back_36:
L_skip_33:
    s_waitcnt vmcnt(7)
    s_barrier
    buffer_load_dwordx4 v[60:63], v28, s[76:79], s90 offen offset:0 sc1
    buffer_load_dwordx4 v[52:55], v30, s[76:79], s91 offen offset:0 sc1
    v_add_u32 v2, 65536, v122
    ds_read_b64_tr_b16 a[0:1], v2 offset:0
    ds_read_b64_tr_b16 a[2:3], v2 offset:2048
    ds_read_b64_tr_b16 a[4:5], v2 offset:8192
    ds_read_b64_tr_b16 a[6:7], v2 offset:10240
    ds_read_b64_tr_b16 a[8:9], v2 offset:16384
    ds_read_b64_tr_b16 a[10:11], v2 offset:18432
    ds_read_b64_tr_b16 a[12:13], v2 offset:24576
    ds_read_b64_tr_b16 a[14:15], v2 offset:26624
    v_add_u32 v2, 98304, v122
    ds_read_b64_tr_b16 a[16:17], v2 offset:0
    ds_read_b64_tr_b16 a[18:19], v2 offset:2048
    ds_read_b64_tr_b16 a[20:21], v2 offset:8192
    ds_read_b64_tr_b16 a[22:23], v2 offset:10240
    ds_read_b64_tr_b16 a[24:25], v2 offset:16384
    ds_read_b64_tr_b16 a[26:27], v2 offset:18432
    ds_read_b64_tr_b16 a[28:29], v2 offset:24576
    ds_read_b64_tr_b16 a[30:31], v2 offset:26624
    v_add_u32 v2, 131072, v122
    ds_read_b64_tr_b16 a[32:33], v2 offset:0
    ds_read_b64_tr_b16 a[34:35], v2 offset:2048
    ds_read_b64_tr_b16 a[36:37], v2 offset:8192
    ds_read_b64_tr_b16 a[38:39], v2 offset:10240
    ds_read_b64_tr_b16 a[40:41], v2 offset:16384
    ds_read_b64_tr_b16 a[42:43], v2 offset:18432
    ds_read_b64_tr_b16 a[44:45], v2 offset:24576
    ds_read_b64_tr_b16 a[46:47], v2 offset:26624
    v_and_b32 v89, 0xffff0000, v96
    v_lshlrev_b32 v88, 16, v96
    v_and_b32 v91, 0xffff0000, v97
    v_lshlrev_b32 v90, 16, v97
    v_and_b32 v93, 0xffff0000, v98
    v_lshlrev_b32 v92, 16, v98
    v_and_b32 v95, 0xffff0000, v99
    v_lshlrev_b32 v94, 16, v99
    v_add_f32 v64, v88, v89
    v_add_f32 v64, v64, v90
    v_add_f32 v64, v64, v91
    v_add_f32 v64, v64, v92
    v_add_f32 v64, v64, v93
    v_add_f32 v64, v64, v94
    v_add_f32 v64, v64, v95
    s_nop 1
    v_add_f32_dpp v64, v64, v64 quad_perm:[1,0,3,2] row_mask:0xf bank_mask:0xf
    s_nop 1
    v_add_f32_dpp v64, v64, v64 quad_perm:[2,3,0,1] row_mask:0xf bank_mask:0xf
    s_nop 1
    v_add_f32_dpp v64, v64, v64 row_half_mirror row_mask:0xf bank_mask:0xf
    s_nop 1
    v_add_f32_dpp v64, v64, v64 row_mirror row_mask:0xf bank_mask:0xf
    v_mov_b32 v65, v64
    s_nop 1
    v_permlane16_swap_b32 v64, v65
    v_add_f32 v64, v64, v65
    v_mov_b32 v65, v64
    s_nop 1
    v_permlane32_swap_b32 v64, v65
    v_add_f32 v64, v64, v65
    v_mul_f32 v64, -0.001953125, v64
    v_add_f32 v96, v88, v64
    v_add_f32 v97, v89, v64
    v_add_f32 v98, v90, v64
    v_add_f32 v99, v91, v64
    v_add_f32 v100, v92, v64
    v_add_f32 v101, v93, v64
    v_add_f32 v102, v94, v64
    v_add_f32 v103, v95, v64
    v_mul_f32 v64, v96, v96
    v_fmac_f32 v64, v97, v97
    v_fmac_f32 v64, v98, v98
    v_fmac_f32 v64, v99, v99
    v_fmac_f32 v64, v100, v100
    v_fmac_f32 v64, v101, v101
    v_fmac_f32 v64, v102, v102
    v_fmac_f32 v64, v103, v103
    s_nop 1
    v_add_f32_dpp v64, v64, v64 quad_perm:[1,0,3,2] row_mask:0xf bank_mask:0xf
    s_nop 1
    v_add_f32_dpp v64, v64, v64 quad_perm:[2,3,0,1] row_mask:0xf bank_mask:0xf
    s_nop 1
    v_add_f32_dpp v64, v64, v64 row_half_mirror row_mask:0xf bank_mask:0xf
    s_nop 1
    v_add_f32_dpp v64, v64, v64 row_mirror row_mask:0xf bank_mask:0xf
    v_mov_b32 v65, v64
    s_nop 1
    v_permlane16_swap_b32 v64, v65
    v_add_f32 v64, v64, v65
    v_mov_b32 v65, v64
    s_nop 1
    v_permlane32_swap_b32 v64, v65
    v_add_f32 v64, v64, v65
    v_mov_b32 v65, 0x3727c5ac
    v_fmac_f32 v65, 0.001953125, v64
    v_rsq_f32 v65, v65
    s_nop 0
    v_mul_f32 v96, v96, v65
    v_mul_f32 v97, v97, v65
    v_mul_f32 v98, v98, v65
    v_mul_f32 v99, v99, v65
    v_mul_f32 v100, v100, v65
    v_mul_f32 v101, v101, v65
    v_mul_f32 v102, v102, v65
    v_mul_f32 v103, v103, v65
    s_waitcnt lgkmcnt(0)
    s_barrier
    s_waitcnt vmcnt(0)
    v_max_u32 v125, v60, v61
    v_max3_u32 v125, v125, v62, v63
    v_max3_u32 v125, v125, v52, v53
    v_max3_u32 v125, v125, v54, v55
    v_cmp_eq_u32 vcc, -1, v125
    s_nop 4
    s_cbranch_vccnz L_retry_41
L_back_40:
    ds_write_b32 v5, v60 offset:0
    ds_write_b32 v5, v61 offset:1040
    ds_write_b32 v5, v62 offset:2080
    ds_write_b32 v5, v63 offset:3120
    ds_write_b128 v31, v[52:55]
    s_waitcnt lgkmcnt(0)
    s_barrier
    ds_read_b128 v[60:63], v6
    ds_read_b128 v[40:43], v4 offset:0
    ds_read_b128 v[44:47], v4 offset:1088
    ds_read_b128 v[32:35], v4 offset:2176
    ds_read_b128 v[36:39], v4 offset:3264
    s_add_u32 s15, s15, 114688
    s_add_u32 m0, s33, 49152
    s_nop 0
    buffer_load_dwordx4 v120, s[56:59], s15 offen lds
    s_lshl_b32 s90, s87, 3
    s_add_u32 s90, s90, s84
    s_lshl_b32 s90, s90, 10
    s_add_u32 s91, s90, 0x700000
    s_add_u32 s90, s90, 0x500000
    s_waitcnt lgkmcnt(4)
    v_and_b32 v17, 0xffff0000, v60
    v_lshlrev_b32 v16, 16, v60
    v_and_b32 v19, 0xffff0000, v61
    v_lshlrev_b32 v18, 16, v61
    v_and_b32 v21, 0xffff0000, v62
    v_lshlrev_b32 v20, 16, v62
    v_and_b32 v23, 0xffff0000, v63
    v_lshlrev_b32 v22, 16, v63
    s_waitcnt lgkmcnt(0)
    v_pk_fma_f32 v[96:97], v[96:97], v[40:41], v[32:33]
    v_pk_fma_f32 v[98:99], v[98:99], v[42:43], v[34:35]
    v_pk_fma_f32 v[100:101], v[100:101], v[44:45], v[36:37]
    v_pk_fma_f32 v[102:103], v[102:103], v[46:47], v[38:39]
    s_add_u32 m0, s33, 50176
    s_nop 0
    buffer_load_dwordx4 v121, s[60:63], s15 offen lds
    v_pk_fma_f32 v[16:17], v[16:17], v[96:97], v[88:89]
    v_pk_fma_f32 v[18:19], v[18:19], v[98:99], v[90:91]
    v_pk_fma_f32 v[20:21], v[20:21], v[100:101], v[92:93]
    v_pk_fma_f32 v[22:23], v[22:23], v[102:103], v[94:95]
    ds_read_b128 v[104:107], v4 offset:4352
    ds_read_b128 v[108:111], v4 offset:5440
    ds_read_b128 v[112:115], v4 offset:6528
    ds_read_b128 v[116:119], v4 offset:7616
    v_pk_add_f32 v[24:25], v[16:17], v[18:19]
    v_pk_mul_f32 v[26:27], v[16:17], v[16:17]
    v_pk_add_f32 v[28:29], v[20:21], v[22:23]
    v_pk_fma_f32 v[26:27], v[18:19], v[18:19], v[26:27]
    v_pk_fma_f32 v[26:27], v[20:21], v[20:21], v[26:27]
    v_pk_fma_f32 v[26:27], v[22:23], v[22:23], v[26:27]
    v_pk_add_f32 v[24:25], v[24:25], v[28:29]
    v_add_f32 v24, v24, v25
    v_add_f32 v25, v26, v27
    v_cvt_pk_bf16_f32 v12, v16, v17
    v_cvt_pk_bf16_f32 v13, v18, v19
    v_cvt_pk_bf16_f32 v14, v20, v21
    v_cvt_pk_bf16_f32 v15, v22, v23
    buffer_store_dwordx4 v[12:15], v7, s[76:79], s91 offen sc1
    v_add_f32_dpp v24, v24, v24 quad_perm:[1,0,3,2] row_mask:0xf bank_mask:0xf
    v_add_f32_dpp v25, v25, v25 quad_perm:[1,0,3,2] row_mask:0xf bank_mask:0xf
    s_nop 0
    v_add_f32_dpp v24, v24, v24 quad_perm:[2,3,0,1] row_mask:0xf bank_mask:0xf
    v_add_f32_dpp v25, v25, v25 quad_perm:[2,3,0,1] row_mask:0xf bank_mask:0xf
    s_nop 0
    v_add_f32_dpp v24, v24, v24 row_half_mirror row_mask:0xf bank_mask:0xf
    v_add_f32_dpp v25, v25, v25 row_half_mirror row_mask:0xf bank_mask:0xf
    s_nop 0
    v_add_f32_dpp v24, v24, v24 row_mirror row_mask:0xf bank_mask:0xf
    v_add_f32_dpp v25, v25, v25 row_mirror row_mask:0xf bank_mask:0xf
    v_mov_b32 v26, v24
    v_mov_b32 v27, v25
    s_nop 0
    v_permlane16_swap_b32 v24, v26
    v_permlane16_swap_b32 v25, v27
    v_add_f32 v24, v24, v26
    v_add_f32 v25, v25, v27
    v_mov_b32 v26, v24
    v_mov_b32 v27, v25
    s_nop 0
    v_permlane32_swap_b32 v24, v26
    v_permlane32_swap_b32 v25, v27
    v_add_f32 v24, v24, v26
    v_add_f32 v25, v25, v27
    v_mul_f32 v24, 0.001953125, v24
    v_mul_f32 v26, v24, v24
    v_mul_f32 v25, 0.001953125, v25
    v_sub_f32 v25, v25, v26
    v_max_f32 v25, 0, v25
    v_add_f32 v25, 0x3727c5ac, v25
    v_rsq_f32 v25, v25
    s_waitcnt lgkmcnt(0)
    v_mul_f32 v24, v24, v25
    v_pk_fma_f32 v[16:17], v[16:17], v[24:25], v[24:25] op_sel:[0,1,0] op_sel_hi:[1,1,0] neg_lo:[0,0,1] neg_hi:[0,0,1]
    v_pk_fma_f32 v[18:19], v[18:19], v[24:25], v[24:25] op_sel:[0,1,0] op_sel_hi:[1,1,0] neg_lo:[0,0,1] neg_hi:[0,0,1]
    v_pk_fma_f32 v[20:21], v[20:21], v[24:25], v[24:25] op_sel:[0,1,0] op_sel_hi:[1,1,0] neg_lo:[0,0,1] neg_hi:[0,0,1]
    v_pk_fma_f32 v[22:23], v[22:23], v[24:25], v[24:25] op_sel:[0,1,0] op_sel_hi:[1,1,0] neg_lo:[0,0,1] neg_hi:[0,0,1]
    v_pk_fma_f32 v[16:17], v[16:17], v[104:105], v[112:113]
    v_pk_fma_f32 v[18:19], v[18:19], v[106:107], v[114:115]
    v_pk_fma_f32 v[20:21], v[20:21], v[108:109], v[116:117]
    v_pk_fma_f32 v[22:23], v[22:23], v[110:111], v[118:119]
    v_cvt_pk_bf16_f32 v8, v16, v17
    v_cvt_pk_bf16_f32 v9, v18, v19
    v_cvt_pk_bf16_f32 v10, v20, v21
    v_cvt_pk_bf16_f32 v11, v22, v23
    v_min_u32 v8, -2, v8
    v_min_u32 v9, -2, v9
    v_min_u32 v10, -2, v10
    v_min_u32 v11, -2, v11
    buffer_store_dwordx4 v[8:11], v7, s[76:79], s90 offen sc1
    v_add_u32 v2, 0, v122
    ds_read_b64_tr_b16 a[48:49], v2 offset:0
    ds_read_b64_tr_b16 a[50:51], v2 offset:2048
    ds_read_b64_tr_b16 a[52:53], v2 offset:8192
    ds_read_b64_tr_b16 a[54:55], v2 offset:10240
    ds_read_b64_tr_b16 a[56:57], v2 offset:16384
    ds_read_b64_tr_b16 a[58:59], v2 offset:18432
    ds_read_b64_tr_b16 a[60:61], v2 offset:24576
    ds_read_b64_tr_b16 a[62:63], v2 offset:26624
    s_add_u32 s15, s4, 5
    s_and_b32 s15, s15, 7
    s_lshl_b32 s15, s15, 4
    s_and_b32 s33, s84, 7
    s_add_u32 s15, s15, s33
    s_mul_i32 s15, s15, 14336
    s_add_u32 s15, s15, s7
    s_lshl_b32 s33, s33, 11
    s_add_u32 m0, s33, 65536
    s_nop 0
    buffer_load_dwordx4 v120, s[56:59], s15 offen lds
    s_add_u32 m0, s33, 66560
    s_nop 0
    buffer_load_dwordx4 v121, s[60:63], s15 offen lds
    s_add_u32 s15, s15, 114688
    s_add_u32 m0, s33, 81920
    s_nop 0
    buffer_load_dwordx4 v120, s[56:59], s15 offen lds
    s_lshl_b32 s90, s4, 3
    v_xor_b32 v2, s84, v1
    v_xor_b32 v3, 8, v2
    v_add_u32 v2, s90, v2
    v_and_b32 v2, 63, v2
    v_lshlrev_b32 v5, 4, v2
    v_add_u32 v3, s90, v3
    v_and_b32 v3, 63, v3
    v_lshlrev_b32 v6, 4, v3
    s_lshl_b32 s11, s84, 10
    s_lshl_b32 s90, s95, 17
    s_add_u32 s10, s90, s11
    s_cmp_lt_u32 s86, 28
    s_cselect_b32 s10, s10, 0x40000000
    v_lshlrev_b32 v56, 4, v0
    v_lshlrev_b32 v0, 2, v1
    s_waitcnt vmcnt(3)
    s_waitcnt lgkmcnt(0)
    s_barrier
    s_add_u32 s92, s5, 0x30000
    s_mov_b32 exec_lo, 0xffff
    s_mov_b32 exec_hi, 0
    buffer_store_dword v126, v0, s[76:79], s92 offen sc1
    s_mov_b64 exec, -1
    s_add_u32 m0, s11, 0
    s_add_u32 s93, s10, 0x500000
    buffer_load_dwordx4 v5, s[76:79], s93 offen sc1 lds
    s_add_u32 m0, s11, 8192
    s_add_u32 s93, s10, 0x502000
    buffer_load_dwordx4 v6, s[76:79], s93 offen sc1 lds
    s_add_u32 m0, s11, 16384
    s_add_u32 s93, s10, 0x504000
    buffer_load_dwordx4 v5, s[76:79], s93 offen sc1 lds
    s_add_u32 m0, s11, 24576
    s_add_u32 s93, s10, 0x506000
    buffer_load_dwordx4 v6, s[76:79], s93 offen sc1 lds
    s_add_u32 m0, s33, 82944
    s_nop 0
    buffer_load_dwordx4 v121, s[60:63], s15 offen lds
    s_add_u32 s15, s4, 6
    s_and_b32 s15, s15, 7
    s_lshl_b32 s15, s15, 4
    s_and_b32 s33, s84, 7
    s_add_u32 s15, s15, s33
    s_mul_i32 s15, s15, 14336
    s_add_u32 s15, s15, s7
    s_lshl_b32 s33, s33, 11
    s_add_u32 m0, s33, 131072
    s_nop 0
    buffer_load_dwordx4 v120, s[56:59], s15 offen lds
    s_add_u32 m0, s33, 132096
    s_nop 0
    buffer_load_dwordx4 v121, s[60:63], s15 offen lds
    v_add_u32 v2, 32768, v122
    ds_read_b64_tr_b16 a[64:65], v2 offset:0
    ds_read_b64_tr_b16 a[66:67], v2 offset:2048
    ds_read_b64_tr_b16 a[68:69], v2 offset:8192
    ds_read_b64_tr_b16 a[70:71], v2 offset:10240
    ds_read_b64_tr_b16 a[72:73], v2 offset:16384
    ds_read_b64_tr_b16 a[74:75], v2 offset:18432
    ds_read_b64_tr_b16 a[76:77], v2 offset:24576
    ds_read_b64_tr_b16 a[78:79], v2 offset:26624
    v_and_b32 v2, 31, v1
    v_lshrrev_b32 v3, 5, v1
    v_and_b32 v4, 15, v1
    v_xor_b32 v4, v4, v3
    v_lshlrev_b32 v4, 4, v4
    v_lshl_add_u32 v104, v2, 10, v4
    v_xor_b32 v105, 32, v104
    v_xor_b32 v106, 64, v104
    v_xor_b32 v107, 96, v104
    v_xor_b32 v108, 128, v104
    v_xor_b32 v109, 160, v104
    v_xor_b32 v110, 192, v104
    v_xor_b32 v111, 224, v104
    s_mul_i32 s90, s95, 458752
    s_lshl_b32 s91, s96, 3
    s_add_u32 s91, s91, s84
    s_lshl_b32 s91, s91, 9
    s_add_u32 s12, s90, s91
    v_bfe_u32 v4, v1, 4, 1
    v_mul_u32_u24 v68, 57344, v4
    v_lshl_add_u32 v68, v3, 8, v68
    v_and_b32 v4, 15, v1
    v_lshl_add_u32 v68, v4, 4, v68
    v_mov_b32 v69, -2.302208198144325
    v_mov_b32 v70, -0.1029432395800235
    s_lshr_b32 s90, s97, 1
    s_lshl_b32 s90, s90, 3
    s_and_b32 s91, s97, 1
    s_add_u32 s90, s90, s91
    s_lshl_b32 s92, s90, 14
    s_lshl_b32 s90, s90, 3
    s_add_u32 s90, s90, s84
    s_mul_i32 s90, s90, 7168
    s_add_u32 s13, s90, 0x900000
    s_lshl_b32 s91, s98, 7
    s_add_u32 s92, s92, s91
    v_lshl_add_u32 v3, v3, 15, s92
    v_bfe_u32 v2, v1, 3, 1
    v_lshl_add_u32 v2, s84, 1, v2
    v_lshl_add_u32 v3, v2, 10, v3
    v_bfe_u32 v2, v1, 4, 1
    v_lshl_add_u32 v3, v2, 6, v3
    v_and_b32 v2, 7, v1
    v_lshl_add_u32 v118, v2, 3, v3
    s_mul_i32 s8, s84, 229376
    s_add_u32 s8, s8, s91
    s_mul_i32 s9, s84, 12288
    s_add_u32 s9, s9, 65536
    v_lshrrev_b32 v2, 3, v1
    v_and_b32 v3, 7, v1
    v_and_b32 v4, 2, v2
    v_lshlrev_b32 v4, 1, v4
    v_xor_b32 v3, v3, v4
    v_lshlrev_b32 v3, 4, v3
    v_lshl_add_u32 v112, v2, 10, v3
    v_xor_b32 v113, 32, v112
    v_bfe_u32 v2, v1, 4, 1
    v_bfe_u32 v3, v1, 2, 2
    v_and_or_b32 v2, v3, 2, v2
    v_lshlrev_b32 v2, 5, v2
    v_lshl_add_u32 v2, v3, 7, v2
    v_and_b32 v3, 3, v1
    v_lshl_add_u32 v2, v3, 3, v2
    v_lshrrev_b32 v3, 4, v1
    v_lshl_add_u32 v2, v3, 10, v2
    v_add_u32 v114, s9, v2
    v_xor_b32 v115, 32, v114
    v_xor_b32 v116, 64, v114
    v_xor_b32 v117, 96, v114
    s_mul_i32 s90, s84, 7
    s_add_u32 s91, s90, 6
    s_lshr_b32 s90, s90, 2
    s_lshr_b32 s91, s91, 2
    v_add_u32 v2, s90, v1
    v_min_u32 v2, s91, v2
    s_lshr_b32 s90, s97, 1
    v_lshl_add_u32 v2, s90, 4, v2
    v_lshlrev_b32 v119, 7, v2
    v_mov_b32 v2, s95
    v_mov_b32 v3, s90
    v_cmp_gt_u32 vcc, 16, v1
    v_and_b32 v4, 15, v1
    s_nop 0
    v_cndmask_b32 v2, v3, v2, vcc
    v_lshl_add_u32 v4, v2, 4, v4
    v_lshlrev_b32 v4, 7, v4
    s_cmp_eq_u32 s84, 1
    s_cbranch_scc0 L_skip_42
    s_cmp_eq_u32 s87, 0
    s_cbranch_scc0 L_skip_42
    s_lshl_b32 s90, s87, 7
    s_add_u32 s90, s90, 0x0
    v_mov_b32 v2, s88
    v_lshlrev_b32 v3, 2, v1
    s_mov_b32 exec_lo, 0xffff
    s_mov_b32 exec_hi, 0
    buffer_store_dword v2, v3, s[76:79], s90 offen sc1
    s_mov_b64 exec, -1
L_skip_42:
    v_add_u32 v2, s11, v7
    s_add_u32 s16, s13, 0
    s_add_u32 s17, s13, 4096
    s_add_u32 s18, s13, 114688
    s_add_u32 s19, s13, 118784
    s_add_u32 s20, s13, 229376
    s_add_u32 s21, s13, 233472
    s_add_u32 s22, s13, 344064
    s_add_u32 s23, s13, 348160
    v_and_b32 v3, 3, v1
    v_lshl_add_u32 v3, s95, 4, v3
    v_lshlrev_b32 v3, 7, v3
    s_waitcnt vmcnt(3)
    ds_read_b128 v[24:27], v2 offset:0
    ds_read_b128 v[28:31], v2 offset:8192
    ds_read_b128 v[32:35], v2 offset:16384
    ds_read_b128 v[36:39], v2 offset:24576
    s_waitcnt lgkmcnt(0)
    v_max_u32 v71, v24, v25
    v_max3_u32 v71, v71, v26, v27
    v_max3_u32 v71, v71, v28, v29
    v_max3_u32 v71, v71, v30, v31
    v_max3_u32 v71, v71, v32, v33
    v_max3_u32 v71, v71, v34, v35
    v_max3_u32 v71, v71, v36, v37
    v_max3_u32 v71, v71, v38, v39
    v_cmp_eq_u32 vcc, -1, v71
    s_nop 4
    s_cbranch_vccnz L_retry_46
L_back_45:
    s_cmp_lt_u32 s86, 28
    s_cbranch_scc0 L_spare_47
    s_waitcnt vmcnt(2)
    s_waitcnt lgkmcnt(0)
    s_barrier
    s_cmp_ge_u32 s84, 4
    s_cbranch_scc0 L_skip_50
    s_setprio 1
L_skip_50:
    ds_read_b128 v[40:43], v104 offset:0
    ds_read_b128 v[44:47], v105 offset:0
    ds_read_b128 v[48:51], v106 offset:0
    ds_read_b128 v[52:55], v107 offset:0
    s_waitcnt lgkmcnt(3)
    v_mfma_f32_32x32x16_bf16 v[8:23], a[0:3], v[40:43], 0
    ds_read_b128 v[40:43], v108 offset:0
    s_add_u32 s15, s15, 114688
    s_add_u32 m0, s33, 147456
    s_nop 0
    buffer_load_dwordx4 v120, s[56:59], s15 offen lds
    v_add_u32 v2, 65536, v122
    ds_read_b64_tr_b16 a[80:81], v2 offset:0
    s_waitcnt lgkmcnt(4)
    v_mfma_f32_32x32x16_bf16 v[8:23], a[4:7], v[44:47], v[8:23]
    ds_read_b128 v[44:47], v109 offset:0
    s_cmp_eq_u32 s84, 4
    s_cbranch_scc0 L_skip_51
    s_mov_b32 s91, 0x30200
    buffer_load_dword v71, v3, s[76:79], s91 offen sc1
L_skip_51:
    s_add_u32 m0, s33, 148480
    s_nop 0
    buffer_load_dwordx4 v121, s[60:63], s15 offen lds
    ds_read_b64_tr_b16 a[82:83], v2 offset:2048
    ds_read_b64_tr_b16 a[84:85], v2 offset:8192
    s_waitcnt lgkmcnt(6)
    v_mfma_f32_32x32x16_bf16 v[8:23], a[8:11], v[48:51], v[8:23]
    ds_read_b128 v[48:51], v110 offset:0
    s_add_u32 s15, s4, 7
    s_and_b32 s15, s15, 7
    s_lshl_b32 s15, s15, 4
    s_and_b32 s33, s84, 7
    s_add_u32 s15, s15, s33
    s_mul_i32 s15, s15, 14336
    s_add_u32 s15, s15, s7
    s_lshl_b32 s33, s33, 11
    s_add_u32 m0, s33, 98304
    s_nop 0
    buffer_load_dwordx4 v120, s[56:59], s15 offen lds
    ds_read_b64_tr_b16 a[86:87], v2 offset:10240
    ds_read_b64_tr_b16 a[88:89], v2 offset:16384
    s_waitcnt lgkmcnt(8)
    v_mfma_f32_32x32x16_bf16 v[8:23], a[12:15], v[52:55], v[8:23]
    ds_read_b128 v[52:55], v111 offset:0
    ds_read_b64_tr_b16 a[90:91], v2 offset:18432
    ds_read_b64_tr_b16 a[92:93], v2 offset:24576
    s_waitcnt lgkmcnt(10)
    v_mfma_f32_32x32x16_bf16 v[8:23], a[16:19], v[40:43], v[8:23]
    ds_read_b128 v[40:43], v104 offset:256
    s_add_u32 m0, s33, 99328
    s_nop 0
    buffer_load_dwordx4 v121, s[60:63], s15 offen lds
    ds_read_b64_tr_b16 a[94:95], v2 offset:26624
    s_waitcnt lgkmcnt(10)
    v_mfma_f32_32x32x16_bf16 v[8:23], a[20:23], v[44:47], v[8:23]
    ds_read_b128 v[44:47], v105 offset:256
    s_waitcnt lgkmcnt(8)
    v_mfma_f32_32x32x16_bf16 v[8:23], a[24:27], v[48:51], v[8:23]
    ds_read_b128 v[48:51], v106 offset:256
    s_add_u32 s15, s15, 114688
    s_add_u32 m0, s33, 114688
    s_nop 0
    buffer_load_dwordx4 v120, s[56:59], s15 offen lds
    s_waitcnt lgkmcnt(6)
    v_mfma_f32_32x32x16_bf16 v[8:23], a[28:31], v[52:55], v[8:23]
    ds_read_b128 v[52:55], v107 offset:256
    s_waitcnt lgkmcnt(4)
    v_mfma_f32_32x32x16_bf16 v[8:23], a[32:35], v[40:43], v[8:23]
    ds_read_b128 v[40:43], v108 offset:256
    s_add_u32 m0, s33, 115712
    s_nop 0
    buffer_load_dwordx4 v121, s[60:63], s15 offen lds
    s_waitcnt lgkmcnt(3)
    v_mfma_f32_32x32x16_bf16 v[8:23], a[36:39], v[44:47], v[8:23]
    ds_read_b128 v[44:47], v109 offset:256
    s_cmp_eq_u32 s84, 4
    s_cbranch_scc0 L_skip_52
    s_waitcnt vmcnt(5)
    v_cmp_ne_u32 vcc, s88, v71
    s_nop 4
    s_cbranch_vccnz L_retry_56
L_back_55:
L_skip_52:
    s_barrier
    s_waitcnt lgkmcnt(3)
    v_mfma_f32_32x32x16_bf16 v[8:23], a[40:43], v[48:51], v[8:23]
    ds_read_b128 v[48:51], v110 offset:256
    s_add_u32 m0, s11, 32768
    s_add_u32 s93, s10, 0x508000
    buffer_load_dwordx4 v5, s[76:79], s93 offen sc1 lds
    s_waitcnt lgkmcnt(3)
    v_mfma_f32_32x32x16_bf16 v[8:23], a[44:47], v[52:55], v[8:23]
    ds_read_b128 v[52:55], v111 offset:256
    s_waitcnt lgkmcnt(3)
    v_mfma_f32_32x32x16_bf16 v[8:23], a[48:51], v[40:43], v[8:23]
    ds_read_b128 v[40:43], v104 offset:512
    s_add_u32 m0, s11, 40960
    s_add_u32 s93, s10, 0x50a000
    buffer_load_dwordx4 v6, s[76:79], s93 offen sc1 lds
    s_waitcnt lgkmcnt(3)
    v_mfma_f32_32x32x16_bf16 v[8:23], a[52:55], v[44:47], v[8:23]
    ds_read_b128 v[44:47], v105 offset:512
    s_waitcnt lgkmcnt(3)
    v_mfma_f32_32x32x16_bf16 v[8:23], a[56:59], v[48:51], v[8:23]
    ds_read_b128 v[48:51], v106 offset:512
    s_add_u32 m0, s11, 49152
    s_add_u32 s93, s10, 0x50c000
    buffer_load_dwordx4 v5, s[76:79], s93 offen sc1 lds
    s_waitcnt lgkmcnt(3)
    v_mfma_f32_32x32x16_bf16 v[8:23], a[60:63], v[52:55], v[8:23]
    ds_read_b128 v[52:55], v107 offset:512
    s_waitcnt lgkmcnt(3)
    v_mfma_f32_32x32x16_bf16 v[8:23], a[64:67], v[40:43], v[8:23]
    ds_read_b128 v[40:43], v108 offset:512
    s_add_u32 m0, s11, 57344
    s_add_u32 s93, s10, 0x50e000
    buffer_load_dwordx4 v6, s[76:79], s93 offen sc1 lds
    s_waitcnt lgkmcnt(3)
    v_mfma_f32_32x32x16_bf16 v[8:23], a[68:71], v[44:47], v[8:23]
    ds_read_b128 v[44:47], v109 offset:512
    s_waitcnt vmcnt(4)
    s_barrier
    v_add_u32 v2, 131072, v122
    ds_read_b64_tr_b16 a[96:97], v2 offset:0
    s_waitcnt lgkmcnt(4)
    v_mfma_f32_32x32x16_bf16 v[8:23], a[72:75], v[48:51], v[8:23]
    ds_read_b128 v[48:51], v110 offset:512
    s_cmp_eq_u32 s84, 4
    s_cbranch_scc0 L_skip_57
    s_mov_b32 s91, 0x30000
    buffer_load_dword v71, v4, s[76:79], s91 offen sc1
L_skip_57:
    ds_read_b64_tr_b16 a[98:99], v2 offset:2048
    ds_read_b64_tr_b16 a[100:101], v2 offset:8192
    s_waitcnt lgkmcnt(6)
    v_mfma_f32_32x32x16_bf16 v[8:23], a[76:79], v[52:55], v[8:23]
    ds_read_b128 v[52:55], v111 offset:512
    ds_read_b64_tr_b16 a[102:103], v2 offset:10240
    ds_read_b64_tr_b16 a[104:105], v2 offset:16384
    s_waitcnt lgkmcnt(8)
    v_mfma_f32_32x32x16_bf16 v[8:23], a[80:83], v[40:43], v[8:23]
    ds_read_b128 v[40:43], v104 offset:768
    ds_read_b64_tr_b16 a[106:107], v2 offset:18432
    ds_read_b64_tr_b16 a[108:109], v2 offset:24576
    s_waitcnt lgkmcnt(10)
    v_mfma_f32_32x32x16_bf16 v[8:23], a[84:87], v[44:47], v[8:23]
    ds_read_b128 v[44:47], v105 offset:768
    ds_read_b64_tr_b16 a[110:111], v2 offset:26624
    v_add_u32 v2, 98304, v122
    s_waitcnt lgkmcnt(10)
    v_mfma_f32_32x32x16_bf16 v[8:23], a[88:91], v[48:51], v[8:23]
    ds_read_b128 v[48:51], v106 offset:768
    ds_read_b64_tr_b16 a[112:113], v2 offset:0
    ds_read_b64_tr_b16 a[114:115], v2 offset:2048
    s_waitcnt lgkmcnt(10)
    v_mfma_f32_32x32x16_bf16 v[8:23], a[92:95], v[52:55], v[8:23]
    ds_read_b128 v[52:55], v107 offset:768
    ds_read_b64_tr_b16 a[116:117], v2 offset:8192
    ds_read_b64_tr_b16 a[118:119], v2 offset:10240
    s_waitcnt lgkmcnt(10)
    v_mfma_f32_32x32x16_bf16 v[8:23], a[96:99], v[40:43], v[8:23]
    ds_read_b128 v[40:43], v108 offset:768
    ds_read_b64_tr_b16 a[120:121], v2 offset:16384
    ds_read_b64_tr_b16 a[122:123], v2 offset:18432
    s_waitcnt lgkmcnt(10)
    v_mfma_f32_32x32x16_bf16 v[8:23], a[100:103], v[44:47], v[8:23]
    ds_read_b128 v[44:47], v109 offset:768
    ds_read_b64_tr_b16 a[124:125], v2 offset:24576
    ds_read_b64_tr_b16 a[126:127], v2 offset:26624
    s_waitcnt lgkmcnt(11)
    v_mfma_f32_32x32x16_bf16 v[8:23], a[104:107], v[48:51], v[8:23]
    ds_read_b128 v[48:51], v110 offset:768
    s_waitcnt lgkmcnt(9)
    v_mfma_f32_32x32x16_bf16 v[8:23], a[108:111], v[52:55], v[8:23]
    ds_read_b128 v[52:55], v111 offset:768
    s_cmp_eq_u32 s84, 4
    s_cbranch_scc0 L_skip_58
    s_waitcnt vmcnt(0)
    v_cmp_ne_u32 vcc, s88, v71
    s_nop 4
    s_cbranch_vccnz L_retry_62
L_back_61:
L_skip_58:
    s_waitcnt vmcnt(0)
    s_waitcnt lgkmcnt(0)
    s_barrier
    v_mfma_f32_32x32x16_bf16 v[8:23], a[112:115], v[40:43], v[8:23]
    ds_read_b128 v[40:43], v104 offset:32768
    s_add_u32 m0, s11, 0
    s_add_u32 s93, s10, 0x510000
    buffer_load_dwordx4 v5, s[76:79], s93 offen sc1 lds
    v_mfma_f32_32x32x16_bf16 v[8:23], a[116:119], v[44:47], v[8:23]
    ds_read_b128 v[44:47], v105 offset:32768
    v_mfma_f32_32x32x16_bf16 v[8:23], a[120:123], v[48:51], v[8:23]
    ds_read_b128 v[48:51], v106 offset:32768
    s_add_u32 m0, s11, 8192
    s_add_u32 s93, s10, 0x512000
    buffer_load_dwordx4 v6, s[76:79], s93 offen sc1 lds
    v_mfma_f32_32x32x16_bf16 v[8:23], a[124:127], v[52:55], v[8:23]
    ds_read_b128 v[52:55], v107 offset:32768
    s_waitcnt lgkmcnt(3)
    v_mfma_f32_32x32x16_bf16 v[24:39], a[0:3], v[40:43], 0
    ds_read_b128 v[40:43], v108 offset:32768
    s_add_u32 m0, s11, 16384
    s_add_u32 s93, s10, 0x514000
    buffer_load_dwordx4 v5, s[76:79], s93 offen sc1 lds
    s_waitcnt lgkmcnt(3)
    v_mfma_f32_32x32x16_bf16 v[24:39], a[4:7], v[44:47], v[24:39]
    ds_read_b128 v[44:47], v109 offset:32768
    s_waitcnt lgkmcnt(3)
    v_mfma_f32_32x32x16_bf16 v[24:39], a[8:11], v[48:51], v[24:39]
    ds_read_b128 v[48:51], v110 offset:32768
    v_mul_f32 v56, v8, v8
    v_mul_f32 v57, v9, v9
    v_mul_f32 v58, v10, v10
    s_add_u32 m0, s11, 24576
    s_add_u32 s93, s10, 0x516000
    buffer_load_dwordx4 v6, s[76:79], s93 offen sc1 lds
    s_waitcnt lgkmcnt(3)
    v_mfma_f32_32x32x16_bf16 v[24:39], a[12:15], v[52:55], v[24:39]
    ds_read_b128 v[52:55], v111 offset:32768
    v_mul_f32 v59, v11, v11
    v_fma_f32 v56, v56, v70, v69
    v_fma_f32 v57, v57, v70, v69
    s_waitcnt lgkmcnt(3)
    v_mfma_f32_32x32x16_bf16 v[24:39], a[16:19], v[40:43], v[24:39]
    ds_read_b128 v[40:43], v104 offset:33024
    v_fma_f32 v58, v58, v70, v69
    v_fma_f32 v59, v59, v70, v69
    v_mul_f32 v56, v56, v8
    s_add_u32 m0, s9, 0
    s_add_u32 s90, s8, 0
    buffer_load_dwordx4 v112, s[64:67], s90 offen lds
    s_waitcnt lgkmcnt(3)
    v_mfma_f32_32x32x16_bf16 v[24:39], a[20:23], v[44:47], v[24:39]
    ds_read_b128 v[44:47], v105 offset:33024
    v_mul_f32 v57, v57, v9
    v_mul_f32 v58, v58, v10
    v_mul_f32 v59, v59, v11
    s_waitcnt lgkmcnt(3)
    v_mfma_f32_32x32x16_bf16 v[24:39], a[24:27], v[48:51], v[24:39]
    ds_read_b128 v[48:51], v106 offset:33024
    v_exp_f32 v56, v56
    v_mul_f32 v60, v8, v16
    v_exp_f32 v57, v57
    s_add_u32 m0, s9, 1024
    s_add_u32 s90, s8, 8192
    buffer_load_dwordx4 v113, s[64:67], s90 offen lds
    s_waitcnt lgkmcnt(3)
    v_mfma_f32_32x32x16_bf16 v[24:39], a[28:31], v[52:55], v[24:39]
    ds_read_b128 v[52:55], v107 offset:33024
    v_mul_f32 v61, v9, v17
    v_exp_f32 v58, v58
    v_mul_f32 v62, v10, v18
    s_waitcnt lgkmcnt(3)
    v_mfma_f32_32x32x16_bf16 v[24:39], a[32:35], v[40:43], v[24:39]
    ds_read_b128 v[40:43], v108 offset:33024
    v_exp_f32 v59, v59
    v_mul_f32 v63, v11, v19
    v_add_f32 v56, 1.0, v56
    s_add_u32 m0, s9, 2048
    s_add_u32 s90, s8, 16384
    buffer_load_dwordx4 v112, s[64:67], s90 offen lds
    s_waitcnt lgkmcnt(3)
    v_mfma_f32_32x32x16_bf16 v[24:39], a[36:39], v[44:47], v[24:39]
    ds_read_b128 v[44:47], v109 offset:33024
    v_add_f32 v57, 1.0, v57
    v_add_f32 v58, 1.0, v58
    v_add_f32 v59, 1.0, v59
    s_waitcnt lgkmcnt(3)
    v_mfma_f32_32x32x16_bf16 v[24:39], a[40:43], v[48:51], v[24:39]
    ds_read_b128 v[48:51], v110 offset:33024
    v_rcp_f32 v56, v56
    v_rcp_f32 v57, v57
    v_rcp_f32 v58, v58
    s_add_u32 m0, s9, 3072
    s_add_u32 s90, s8, 24576
    buffer_load_dwordx4 v113, s[64:67], s90 offen lds
    s_waitcnt lgkmcnt(3)
    v_mfma_f32_32x32x16_bf16 v[24:39], a[44:47], v[52:55], v[24:39]
    ds_read_b128 v[52:55], v111 offset:33024
    v_rcp_f32 v59, v59
    v_mul_f32 v60, v60, v56
    v_mul_f32 v61, v61, v57
    s_waitcnt lgkmcnt(3)
    v_mfma_f32_32x32x16_bf16 v[24:39], a[48:51], v[40:43], v[24:39]
    ds_read_b128 v[40:43], v104 offset:33280
    v_mul_f32 v62, v62, v58
    v_mul_f32 v63, v63, v59
    v_cvt_pk_bf16_f32 v64, v60, v61
    s_add_u32 m0, s9, 4096
    s_add_u32 s90, s8, 32768
    buffer_load_dwordx4 v112, s[64:67], s90 offen lds
    s_waitcnt lgkmcnt(3)
    v_mfma_f32_32x32x16_bf16 v[24:39], a[52:55], v[44:47], v[24:39]
    ds_read_b128 v[44:47], v105 offset:33280
    v_cvt_pk_bf16_f32 v65, v62, v63
    v_mul_f32 v56, v12, v12
    v_mul_f32 v57, v13, v13
    s_waitcnt lgkmcnt(3)
    v_mfma_f32_32x32x16_bf16 v[24:39], a[56:59], v[48:51], v[24:39]
    ds_read_b128 v[48:51], v106 offset:33280
    v_mul_f32 v58, v14, v14
    v_mul_f32 v59, v15, v15
    v_fma_f32 v56, v56, v70, v69
    s_add_u32 m0, s9, 5120
    s_add_u32 s90, s8, 40960
    buffer_load_dwordx4 v113, s[64:67], s90 offen lds
    s_waitcnt lgkmcnt(3)
    v_mfma_f32_32x32x16_bf16 v[24:39], a[60:63], v[52:55], v[24:39]
    ds_read_b128 v[52:55], v107 offset:33280
    v_fma_f32 v57, v57, v70, v69
    v_fma_f32 v58, v58, v70, v69
    v_fma_f32 v59, v59, v70, v69
    s_waitcnt lgkmcnt(3)
    v_mfma_f32_32x32x16_bf16 v[24:39], a[64:67], v[40:43], v[24:39]
    ds_read_b128 v[40:43], v108 offset:33280
    v_mul_f32 v56, v56, v12
    v_mul_f32 v57, v57, v13
    v_mul_f32 v58, v58, v14
    s_add_u32 m0, s9, 6144
    s_add_u32 s90, s8, 49152
    buffer_load_dwordx4 v112, s[64:67], s90 offen lds
    s_waitcnt lgkmcnt(3)
    v_mfma_f32_32x32x16_bf16 v[24:39], a[68:71], v[44:47], v[24:39]
    ds_read_b128 v[44:47], v109 offset:33280
    v_mul_f32 v59, v59, v15
    v_exp_f32 v56, v56
    v_mul_f32 v60, v12, v20
    s_waitcnt lgkmcnt(3)
    v_mfma_f32_32x32x16_bf16 v[24:39], a[72:75], v[48:51], v[24:39]
    ds_read_b128 v[48:51], v110 offset:33280
    v_exp_f32 v57, v57
    v_mul_f32 v61, v13, v21
    v_exp_f32 v58, v58
    s_add_u32 m0, s9, 7168
    s_add_u32 s90, s8, 57344
    buffer_load_dwordx4 v113, s[64:67], s90 offen lds
    s_waitcnt lgkmcnt(3)
    v_mfma_f32_32x32x16_bf16 v[24:39], a[76:79], v[52:55], v[24:39]
    ds_read_b128 v[52:55], v111 offset:33280
    v_mul_f32 v62, v14, v22
    v_exp_f32 v59, v59
    v_mul_f32 v63, v15, v23
    s_waitcnt lgkmcnt(3)
    v_mfma_f32_32x32x16_bf16 v[24:39], a[80:83], v[40:43], v[24:39]
    ds_read_b128 v[40:43], v104 offset:33536
    v_add_f32 v56, 1.0, v56
    v_add_f32 v57, 1.0, v57
    v_add_f32 v58, 1.0, v58
    s_waitcnt lgkmcnt(3)
    v_mfma_f32_32x32x16_bf16 v[24:39], a[84:87], v[44:47], v[24:39]
    ds_read_b128 v[44:47], v105 offset:33536
    v_add_f32 v59, 1.0, v59
    v_rcp_f32 v56, v56
    v_rcp_f32 v57, v57
    s_waitcnt lgkmcnt(3)
    v_mfma_f32_32x32x16_bf16 v[24:39], a[88:91], v[48:51], v[24:39]
    ds_read_b128 v[48:51], v106 offset:33536
    v_rcp_f32 v58, v58
    v_rcp_f32 v59, v59
    v_mul_f32 v60, v60, v56
    s_waitcnt lgkmcnt(3)
    v_mfma_f32_32x32x16_bf16 v[24:39], a[92:95], v[52:55], v[24:39]
    ds_read_b128 v[52:55], v107 offset:33536
    v_mul_f32 v61, v61, v57
    v_mul_f32 v62, v62, v58
    v_mul_f32 v63, v63, v59
    s_waitcnt lgkmcnt(3)
    v_mfma_f32_32x32x16_bf16 v[24:39], a[96:99], v[40:43], v[24:39]
    ds_read_b128 v[40:43], v108 offset:33536
    v_cvt_pk_bf16_f32 v66, v60, v61
    v_cvt_pk_bf16_f32 v67, v62, v63
    s_add_u32 s93, s12, 0x900000
    buffer_store_dwordx4 v[64:67], v68, s[76:79], s93 offen sc1
    s_waitcnt lgkmcnt(3)
    v_mfma_f32_32x32x16_bf16 v[24:39], a[100:103], v[44:47], v[24:39]
    ds_read_b128 v[44:47], v109 offset:33536
    s_waitcnt lgkmcnt(3)
    v_mfma_f32_32x32x16_bf16 v[24:39], a[104:107], v[48:51], v[24:39]
    ds_read_b128 v[48:51], v110 offset:33536
    s_waitcnt vmcnt(5)
    ds_read_b64_tr_b16 v[72:73], v114 offset:0
    s_waitcnt lgkmcnt(4)
    v_mfma_f32_32x32x16_bf16 v[24:39], a[108:111], v[52:55], v[24:39]
    ds_read_b128 v[52:55], v111 offset:33536
    s_waitcnt lgkmcnt(0)
    s_barrier
    ds_read_b64_tr_b16 v[74:75], v114 offset:512
    ds_read_b64_tr_b16 v[76:77], v115 offset:0
    v_mfma_f32_32x32x16_bf16 v[24:39], a[112:115], v[40:43], v[24:39]
    ds_read_b128 v[40:43], v104 offset:0
    s_add_u32 m0, s11, 32768
    s_add_u32 s93, s10, 0x518000
    buffer_load_dwordx4 v5, s[76:79], s93 offen sc1 lds
    ds_read_b64_tr_b16 v[78:79], v115 offset:512
    ds_read_b64_tr_b16 v[80:81], v116 offset:0
    v_mfma_f32_32x32x16_bf16 v[24:39], a[116:119], v[44:47], v[24:39]
    ds_read_b128 v[44:47], v105 offset:0
    ds_read_b64_tr_b16 v[82:83], v116 offset:512
    ds_read_b64_tr_b16 v[84:85], v117 offset:0
    v_mfma_f32_32x32x16_bf16 v[24:39], a[120:123], v[48:51], v[24:39]
    ds_read_b128 v[48:51], v106 offset:0
    s_add_u32 m0, s11, 40960
    s_add_u32 s93, s10, 0x51a000
    buffer_load_dwordx4 v6, s[76:79], s93 offen sc1 lds
    ds_read_b64_tr_b16 v[86:87], v117 offset:512
    v_mfma_f32_32x32x16_bf16 v[24:39], a[124:127], v[52:55], v[24:39]
    ds_read_b128 v[52:55], v107 offset:0
    s_waitcnt lgkmcnt(8)
    v_mfma_f32_32x32x16_bf16 v[8:23], a[0:3], v[40:43], 0
    ds_read_b128 v[40:43], v108 offset:0
    s_add_u32 m0, s11, 49152
    s_add_u32 s93, s10, 0x51c000
    buffer_load_dwordx4 v5, s[76:79], s93 offen sc1 lds
    s_waitcnt lgkmcnt(6)
    v_mfma_f32_32x32x16_bf16 v[8:23], a[4:7], v[44:47], v[8:23]
    ds_read_b128 v[44:47], v109 offset:0
    s_waitcnt lgkmcnt(4)
    v_mfma_f32_32x32x16_bf16 v[8:23], a[8:11], v[48:51], v[8:23]
    ds_read_b128 v[48:51], v110 offset:0
    v_mul_f32 v56, v24, v24
    v_mul_f32 v57, v25, v25
    v_mul_f32 v58, v26, v26
    s_add_u32 m0, s11, 57344
    s_add_u32 s93, s10, 0x51e000
    buffer_load_dwordx4 v6, s[76:79], s93 offen sc1 lds
    s_waitcnt vmcnt(5)
    ds_read_b64_tr_b16 v[88:89], v114 offset:4096
    s_waitcnt lgkmcnt(4)
    v_mfma_f32_32x32x16_bf16 v[8:23], a[12:15], v[52:55], v[8:23]
    ds_read_b128 v[52:55], v111 offset:0
    v_mul_f32 v59, v27, v27
    v_fma_f32 v56, v56, v70, v69
    v_fma_f32 v57, v57, v70, v69
    ds_read_b64_tr_b16 v[90:91], v114 offset:4608
    ds_read_b64_tr_b16 v[92:93], v115 offset:4096
    s_waitcnt lgkmcnt(6)
    v_mfma_f32_32x32x16_bf16 v[8:23], a[16:19], v[40:43], v[8:23]
    ds_read_b128 v[40:43], v104 offset:256
    v_fma_f32 v58, v58, v70, v69
    v_fma_f32 v59, v59, v70, v69
    v_mul_f32 v56, v56, v24
    s_add_u32 m0, s9, 8192
    s_add_u32 s90, s8, 65536
    buffer_load_dwordx4 v112, s[64:67], s90 offen lds
    ds_read_b64_tr_b16 v[94:95], v115 offset:4608
    ds_read_b64_tr_b16 v[96:97], v116 offset:4096
    s_waitcnt lgkmcnt(8)
    v_mfma_f32_32x32x16_bf16 v[8:23], a[20:23], v[44:47], v[8:23]
    ds_read_b128 v[44:47], v105 offset:256
    v_mul_f32 v57, v57, v25
    v_mul_f32 v58, v58, v26
    v_mul_f32 v59, v59, v27
    ds_read_b64_tr_b16 v[98:99], v116 offset:4608
    ds_read_b64_tr_b16 v[100:101], v117 offset:4096
    s_waitcnt lgkmcnt(10)
    v_mfma_f32_32x32x16_bf16 v[8:23], a[24:27], v[48:51], v[8:23]
    ds_read_b128 v[48:51], v106 offset:256
    v_exp_f32 v56, v56
    v_mul_f32 v60, v24, v32
    v_exp_f32 v57, v57
    s_add_u32 m0, s9, 9216
    s_add_u32 s90, s8, 73728
    buffer_load_dwordx4 v113, s[64:67], s90 offen lds
    ds_read_b64_tr_b16 v[102:103], v117 offset:4608
    s_waitcnt lgkmcnt(10)
    v_mfma_f32_32x32x16_bf16 v[8:23], a[28:31], v[52:55], v[8:23]
    ds_read_b128 v[52:55], v107 offset:256
    v_mul_f32 v61, v25, v33
    v_exp_f32 v58, v58
    v_mul_f32 v62, v26, v34
    s_waitcnt lgkmcnt(8)
    v_mfma_f32_32x32x16_bf16 v[8:23], a[32:35], v[40:43], v[8:23]
    ds_read_b128 v[40:43], v108 offset:256
    v_exp_f32 v59, v59
    v_mul_f32 v63, v27, v35
    v_add_f32 v56, 1.0, v56
    s_add_u32 m0, s9, 10240
    s_add_u32 s90, s8, 81920
    buffer_load_dwordx4 v112, s[64:67], s90 offen lds
    s_waitcnt lgkmcnt(6)
    v_mfma_f32_32x32x16_bf16 v[8:23], a[36:39], v[44:47], v[8:23]
    ds_read_b128 v[44:47], v109 offset:256
    v_add_f32 v57, 1.0, v57
    v_add_f32 v58, 1.0, v58
    v_add_f32 v59, 1.0, v59
    s_waitcnt lgkmcnt(4)
    v_mfma_f32_32x32x16_bf16 v[8:23], a[40:43], v[48:51], v[8:23]
    ds_read_b128 v[48:51], v110 offset:256
    v_rcp_f32 v56, v56
    v_rcp_f32 v57, v57
    v_rcp_f32 v58, v58
    s_add_u32 m0, s9, 11264
    s_add_u32 s90, s8, 90112
    buffer_load_dwordx4 v113, s[64:67], s90 offen lds
    s_waitcnt lgkmcnt(3)
    v_mfma_f32_32x32x16_bf16 v[8:23], a[44:47], v[52:55], v[8:23]
    ds_read_b128 v[52:55], v111 offset:256
    v_rcp_f32 v59, v59
    v_mul_f32 v60, v60, v56
    v_mul_f32 v61, v61, v57
    s_waitcnt lgkmcnt(3)
    v_mfma_f32_32x32x16_bf16 v[8:23], a[48:51], v[40:43], v[8:23]
    ds_read_b128 v[40:43], v104 offset:512
    v_mul_f32 v62, v62, v58
    v_mul_f32 v63, v63, v59
    v_cvt_pk_bf16_f32 v64, v60, v61
    s_add_u32 m0, s9, 0
    s_add_u32 s90, s8, 98304
    buffer_load_dwordx4 v112, s[64:67], s90 offen lds
    s_waitcnt lgkmcnt(3)
    v_mfma_f32_32x32x16_bf16 v[8:23], a[52:55], v[44:47], v[8:23]
    ds_read_b128 v[44:47], v105 offset:512
    v_cvt_pk_bf16_f32 v65, v62, v63
    v_mul_f32 v56, v28, v28
    v_mul_f32 v57, v29, v29
    s_waitcnt lgkmcnt(3)
    v_mfma_f32_32x32x16_bf16 v[8:23], a[56:59], v[48:51], v[8:23]
    ds_read_b128 v[48:51], v106 offset:512
    v_mul_f32 v58, v30, v30
    v_mul_f32 v59, v31, v31
    v_fma_f32 v56, v56, v70, v69
    s_add_u32 m0, s9, 1024
    s_add_u32 s90, s8, 106496
    buffer_load_dwordx4 v113, s[64:67], s90 offen lds
    s_waitcnt lgkmcnt(3)
    v_mfma_f32_32x32x16_bf16 v[8:23], a[60:63], v[52:55], v[8:23]
    ds_read_b128 v[52:55], v107 offset:512
    v_fma_f32 v57, v57, v70, v69
    v_fma_f32 v58, v58, v70, v69
    v_fma_f32 v59, v59, v70, v69
    s_waitcnt lgkmcnt(3)
    v_mfma_f32_32x32x16_bf16 v[8:23], a[64:67], v[40:43], v[8:23]
    ds_read_b128 v[40:43], v108 offset:512
    v_mul_f32 v56, v56, v28
    v_mul_f32 v57, v57, v29
    v_mul_f32 v58, v58, v30
    s_add_u32 m0, s9, 2048
    s_add_u32 s90, s8, 114688
    buffer_load_dwordx4 v112, s[64:67], s90 offen lds
    s_waitcnt lgkmcnt(3)
    v_mfma_f32_32x32x16_bf16 v[8:23], a[68:71], v[44:47], v[8:23]
    ds_read_b128 v[44:47], v109 offset:512
    v_mul_f32 v59, v59, v31
    v_exp_f32 v56, v56
    v_mul_f32 v60, v28, v36
    s_waitcnt lgkmcnt(3)
    v_mfma_f32_32x32x16_bf16 v[8:23], a[72:75], v[48:51], v[8:23]
    ds_read_b128 v[48:51], v110 offset:512
    v_exp_f32 v57, v57
    v_mul_f32 v61, v29, v37
    v_exp_f32 v58, v58
    s_add_u32 m0, s9, 3072
    s_add_u32 s90, s8, 122880
    buffer_load_dwordx4 v113, s[64:67], s90 offen lds
    s_waitcnt lgkmcnt(3)
    v_mfma_f32_32x32x16_bf16 v[8:23], a[76:79], v[52:55], v[8:23]
    ds_read_b128 v[52:55], v111 offset:512
    v_mul_f32 v62, v30, v38
    v_exp_f32 v59, v59
    v_mul_f32 v63, v31, v39
    s_waitcnt lgkmcnt(3)
    v_mfma_f32_32x32x16_bf16 v[8:23], a[80:83], v[40:43], v[8:23]
    ds_read_b128 v[40:43], v104 offset:768
    v_add_f32 v56, 1.0, v56
    v_add_f32 v57, 1.0, v57
    v_add_f32 v58, 1.0, v58
    v_and_b32 v4, 0x3ff, v118
    v_lshlrev_b32 v4, 1, v4
    s_mov_b32 s90, 0x52000
    buffer_load_dwordx4 v[120:123], v4, s[76:79], s90 offen sc1
    s_waitcnt lgkmcnt(3)
    v_mfma_f32_32x32x16_bf16 v[8:23], a[84:87], v[44:47], v[8:23]
    ds_read_b128 v[44:47], v105 offset:768
    v_add_f32 v59, 1.0, v59
    v_rcp_f32 v56, v56
    v_rcp_f32 v57, v57
    s_waitcnt lgkmcnt(3)
    v_mfma_f32_32x32x16_bf16 v[8:23], a[88:91], v[48:51], v[8:23]
    ds_read_b128 v[48:51], v106 offset:768
    v_rcp_f32 v58, v58
    v_rcp_f32 v59, v59
    v_mul_f32 v60, v60, v56
    s_mov_b32 s90, 0x700000
    buffer_load_dwordx2 v[2:3], v118, s[76:79], s90 offen sc1
    s_waitcnt lgkmcnt(3)
    v_mfma_f32_32x32x16_bf16 v[8:23], a[92:95], v[52:55], v[8:23]
    ds_read_b128 v[52:55], v107 offset:768
    v_mul_f32 v61, v61, v57
    v_mul_f32 v62, v62, v58
    v_mul_f32 v63, v63, v59
    s_waitcnt lgkmcnt(3)
    v_mfma_f32_32x32x16_bf16 v[8:23], a[96:99], v[40:43], v[8:23]
    ds_read_b128 v[40:43], v108 offset:768
    v_cvt_pk_bf16_f32 v66, v60, v61
    v_cvt_pk_bf16_f32 v67, v62, v63
    s_add_u32 s93, s12, 0x91c000
    buffer_store_dwordx4 v[64:67], v68, s[76:79], s93 offen sc1
    s_mov_b32 s90, 0x710000
    buffer_load_dwordx2 v[124:125], v118, s[76:79], s90 offen sc1
    s_waitcnt lgkmcnt(3)
    v_mfma_f32_32x32x16_bf16 v[8:23], a[100:103], v[44:47], v[8:23]
    ds_read_b128 v[44:47], v109 offset:768
    s_waitcnt lgkmcnt(3)
    v_mfma_f32_32x32x16_bf16 v[8:23], a[104:107], v[48:51], v[8:23]
    ds_read_b128 v[48:51], v110 offset:768
    s_waitcnt lgkmcnt(3)
    v_mfma_f32_32x32x16_bf16 v[8:23], a[108:111], v[52:55], v[8:23]
    ds_read_b128 v[52:55], v111 offset:768
    s_waitcnt vmcnt(12)
    s_barrier
    s_add_u32 s92, s6, 0xe0000
    s_mov_b32 exec_lo, 0xffff
    s_mov_b32 exec_hi, 0
    buffer_store_dword v126, v0, s[76:79], s92 offen sc1
    s_mov_b64 exec, -1
    s_waitcnt lgkmcnt(3)
    v_mfma_f32_32x32x16_bf16 v[8:23], a[112:115], v[40:43], v[8:23]
    ds_read_b128 v[40:43], v104 offset:32768
    s_add_u32 m0, s9, 4096
    s_add_u32 s90, s8, 131072
    buffer_load_dwordx4 v112, s[64:67], s90 offen lds
    s_waitcnt lgkmcnt(3)
    v_mfma_f32_32x32x16_bf16 v[8:23], a[116:119], v[44:47], v[8:23]
    ds_read_b128 v[44:47], v105 offset:32768
    s_waitcnt lgkmcnt(3)
    v_mfma_f32_32x32x16_bf16 v[8:23], a[120:123], v[48:51], v[8:23]
    ds_read_b128 v[48:51], v106 offset:32768
    s_add_u32 m0, s9, 5120
    s_add_u32 s90, s8, 139264
    buffer_load_dwordx4 v113, s[64:67], s90 offen lds
    s_waitcnt lgkmcnt(3)
    v_mfma_f32_32x32x16_bf16 v[8:23], a[124:127], v[52:55], v[8:23]
    ds_read_b128 v[52:55], v107 offset:32768
    s_waitcnt lgkmcnt(3)
    v_mfma_f32_32x32x16_bf16 v[24:39], a[0:3], v[40:43], 0
    ds_read_b128 v[40:43], v108 offset:32768
    s_add_u32 m0, s9, 6144
    s_add_u32 s90, s8, 147456
    buffer_load_dwordx4 v112, s[64:67], s90 offen lds
    s_waitcnt lgkmcnt(3)
    v_mfma_f32_32x32x16_bf16 v[24:39], a[4:7], v[44:47], v[24:39]
    ds_read_b128 v[44:47], v109 offset:32768
    s_waitcnt lgkmcnt(3)
    v_mfma_f32_32x32x16_bf16 v[24:39], a[8:11], v[48:51], v[24:39]
    ds_read_b128 v[48:51], v110 offset:32768
    v_mul_f32 v56, v8, v8
    v_mul_f32 v57, v9, v9
    v_mul_f32 v58, v10, v10
    s_add_u32 m0, s9, 7168
    s_add_u32 s90, s8, 155648
    buffer_load_dwordx4 v113, s[64:67], s90 offen lds
    s_waitcnt lgkmcnt(3)
    v_mfma_f32_32x32x16_bf16 v[24:39], a[12:15], v[52:55], v[24:39]
    ds_read_b128 v[52:55], v111 offset:32768
    v_mul_f32 v59, v11, v11
    v_fma_f32 v56, v56, v70, v69
    v_fma_f32 v57, v57, v70, v69
    s_waitcnt vmcnt(13)
    ds_read_b64_tr_b16 a[0:1], v114 offset:8192
    s_waitcnt lgkmcnt(4)
    v_mfma_f32_32x32x16_bf16 v[24:39], a[16:19], v[40:43], v[24:39]
    ds_read_b128 v[40:43], v104 offset:33024
    v_fma_f32 v58, v58, v70, v69
    v_fma_f32 v59, v59, v70, v69
    v_mul_f32 v56, v56, v8
    ds_read_b64_tr_b16 a[2:3], v114 offset:8704
    ds_read_b64_tr_b16 a[4:5], v115 offset:8192
    s_waitcnt lgkmcnt(6)
    v_mfma_f32_32x32x16_bf16 v[24:39], a[20:23], v[44:47], v[24:39]
    ds_read_b128 v[44:47], v105 offset:33024
    v_mul_f32 v57, v57, v9
    v_mul_f32 v58, v58, v10
    v_mul_f32 v59, v59, v11
    ds_read_b64_tr_b16 a[6:7], v115 offset:8704
    ds_read_b64_tr_b16 a[8:9], v116 offset:8192
    s_waitcnt lgkmcnt(8)
    v_mfma_f32_32x32x16_bf16 v[24:39], a[24:27], v[48:51], v[24:39]
    ds_read_b128 v[48:51], v106 offset:33024
    v_exp_f32 v56, v56
    v_mul_f32 v60, v8, v16
    v_exp_f32 v57, v57
    ds_read_b64_tr_b16 a[10:11], v116 offset:8704
    ds_read_b64_tr_b16 a[12:13], v117 offset:8192
    s_waitcnt lgkmcnt(10)
    v_mfma_f32_32x32x16_bf16 v[24:39], a[28:31], v[52:55], v[24:39]
    ds_read_b128 v[52:55], v107 offset:33024
    v_mul_f32 v61, v9, v17
    v_exp_f32 v58, v58
    v_mul_f32 v62, v10, v18
    ds_read_b64_tr_b16 a[14:15], v117 offset:8704
    s_waitcnt vmcnt(9)
    s_waitcnt lgkmcnt(10)
    v_mfma_f32_32x32x16_bf16 v[24:39], a[32:35], v[40:43], v[24:39]
    ds_read_b128 v[40:43], v108 offset:33024
    v_exp_f32 v59, v59
    v_mul_f32 v63, v11, v19
    v_add_f32 v56, 1.0, v56
    s_waitcnt lgkmcnt(1)
    s_add_u32 m0, s9, 8192
    s_add_u32 s90, s8, 163840
    buffer_load_dwordx4 v112, s[64:67], s90 offen lds
    ds_read_b64_tr_b16 a[16:17], v114 offset:0
    ds_read_b64_tr_b16 a[18:19], v114 offset:512
    v_mfma_f32_32x32x16_bf16 v[24:39], a[36:39], v[44:47], v[24:39]
    ds_read_b128 v[44:47], v109 offset:33024
    v_add_f32 v57, 1.0, v57
    v_add_f32 v58, 1.0, v58
    v_add_f32 v59, 1.0, v59
    ds_read_b64_tr_b16 a[20:21], v115 offset:0
    ds_read_b64_tr_b16 a[22:23], v115 offset:512
    v_mfma_f32_32x32x16_bf16 v[24:39], a[40:43], v[48:51], v[24:39]
    ds_read_b128 v[48:51], v110 offset:33024
    s_waitcnt vmcnt(7)
    s_barrier
    s_add_u32 s92, s6, 0xe8000
    s_mov_b32 exec_lo, 0xffff
    s_mov_b32 exec_hi, 0
    buffer_store_dword v126, v0, s[76:79], s92 offen sc1
    s_mov_b64 exec, -1
    v_rcp_f32 v56, v56
    v_rcp_f32 v57, v57
    v_rcp_f32 v58, v58
    s_add_u32 m0, s9, 9216
    s_add_u32 s90, s8, 172032
    buffer_load_dwordx4 v113, s[64:67], s90 offen lds
    ds_read_b64_tr_b16 a[24:25], v116 offset:0
    ds_read_b64_tr_b16 a[26:27], v116 offset:512
    v_mfma_f32_32x32x16_bf16 v[24:39], a[44:47], v[52:55], v[24:39]
    ds_read_b128 v[52:55], v111 offset:33024
    v_rcp_f32 v59, v59
    v_mul_f32 v60, v60, v56
    v_mul_f32 v61, v61, v57
    ds_read_b64_tr_b16 a[28:29], v117 offset:0
    ds_read_b64_tr_b16 a[30:31], v117 offset:512
    s_waitcnt lgkmcnt(11)
    v_mfma_f32_32x32x16_bf16 v[24:39], a[48:51], v[40:43], v[24:39]
    ds_read_b128 v[40:43], v104 offset:33280
    v_mul_f32 v62, v62, v58
    v_mul_f32 v63, v63, v59
    v_cvt_pk_bf16_f32 v64, v60, v61
    s_add_u32 m0, s9, 10240
    s_add_u32 s90, s8, 180224
    buffer_load_dwordx4 v112, s[64:67], s90 offen lds
    s_waitcnt lgkmcnt(9)
    v_mfma_f32_32x32x16_bf16 v[24:39], a[52:55], v[44:47], v[24:39]
    ds_read_b128 v[44:47], v105 offset:33280
    v_cvt_pk_bf16_f32 v65, v62, v63
    v_mul_f32 v56, v12, v12
    v_mul_f32 v57, v13, v13
    s_waitcnt lgkmcnt(7)
    v_mfma_f32_32x32x16_bf16 v[24:39], a[56:59], v[48:51], v[24:39]
    ds_read_b128 v[48:51], v106 offset:33280
    v_mul_f32 v58, v14, v14
    v_mul_f32 v59, v15, v15
    v_fma_f32 v56, v56, v70, v69
    s_add_u32 m0, s9, 11264
    s_add_u32 s90, s8, 188416
    buffer_load_dwordx4 v113, s[64:67], s90 offen lds
    s_waitcnt lgkmcnt(5)
    v_mfma_f32_32x32x16_bf16 v[24:39], a[60:63], v[52:55], v[24:39]
    ds_read_b128 v[52:55], v107 offset:33280
    v_fma_f32 v57, v57, v70, v69
    v_fma_f32 v58, v58, v70, v69
    v_fma_f32 v59, v59, v70, v69
    s_waitcnt lgkmcnt(3)
    v_mfma_f32_32x32x16_bf16 v[24:39], a[64:67], v[40:43], v[24:39]
    ds_read_b128 v[40:43], v108 offset:33280
    v_mul_f32 v56, v56, v12
    v_mul_f32 v57, v57, v13
    v_mul_f32 v58, v58, v14
    s_mov_b32 s91, 0xe0000
    buffer_load_dword v71, v119, s[76:79], s91 offen sc1
    s_waitcnt lgkmcnt(3)
    v_mfma_f32_32x32x16_bf16 v[24:39], a[68:71], v[44:47], v[24:39]
    ds_read_b128 v[44:47], v109 offset:33280
    v_mul_f32 v59, v59, v15
    v_exp_f32 v56, v56
    v_mul_f32 v60, v12, v20
    s_waitcnt vmcnt(6)
    ds_read_b64_tr_b16 a[32:33], v114 offset:4096
    s_waitcnt lgkmcnt(4)
    v_mfma_f32_32x32x16_bf16 v[24:39], a[72:75], v[48:51], v[24:39]
    ds_read_b128 v[48:51], v110 offset:33280
    v_exp_f32 v57, v57
    v_mul_f32 v61, v13, v21
    v_exp_f32 v58, v58
    s_add_u32 m0, s9, 0
    s_add_u32 s90, s8, 196608
    buffer_load_dwordx4 v112, s[64:67], s90 offen lds
    ds_read_b64_tr_b16 a[34:35], v114 offset:4608
    ds_read_b64_tr_b16 a[36:37], v115 offset:4096
    s_waitcnt lgkmcnt(6)
    v_mfma_f32_32x32x16_bf16 v[24:39], a[76:79], v[52:55], v[24:39]
    ds_read_b128 v[52:55], v111 offset:33280
    v_mul_f32 v62, v14, v22
    v_exp_f32 v59, v59
    v_mul_f32 v63, v15, v23
    ds_read_b64_tr_b16 a[38:39], v115 offset:4608
    ds_read_b64_tr_b16 a[40:41], v116 offset:4096
    s_waitcnt lgkmcnt(8)
    v_mfma_f32_32x32x16_bf16 v[24:39], a[80:83], v[40:43], v[24:39]
    ds_read_b128 v[40:43], v104 offset:33536
    v_add_f32 v56, 1.0, v56
    v_add_f32 v57, 1.0, v57
    v_add_f32 v58, 1.0, v58
    s_add_u32 m0, s9, 1024
    s_add_u32 s90, s8, 204800
    buffer_load_dwordx4 v113, s[64:67], s90 offen lds
    ds_read_b64_tr_b16 a[42:43], v116 offset:4608
    ds_read_b64_tr_b16 a[44:45], v117 offset:4096
    s_waitcnt lgkmcnt(10)
    v_mfma_f32_32x32x16_bf16 v[24:39], a[84:87], v[44:47], v[24:39]
    ds_read_b128 v[44:47], v105 offset:33536
    v_add_f32 v59, 1.0, v59
    v_rcp_f32 v56, v56
    v_rcp_f32 v57, v57
    ds_read_b64_tr_b16 a[46:47], v117 offset:4608
    s_waitcnt lgkmcnt(10)
    v_mfma_f32_32x32x16_bf16 v[24:39], a[88:91], v[48:51], v[24:39]
    ds_read_b128 v[48:51], v106 offset:33536
    v_rcp_f32 v58, v58
    v_rcp_f32 v59, v59
    v_mul_f32 v60, v60, v56
    s_add_u32 m0, s9, 2048
    s_add_u32 s90, s8, 212992
    buffer_load_dwordx4 v112, s[64:67], s90 offen lds
    s_waitcnt lgkmcnt(8)
    v_mfma_f32_32x32x16_bf16 v[24:39], a[92:95], v[52:55], v[24:39]
    ds_read_b128 v[52:55], v107 offset:33536
    v_mul_f32 v61, v61, v57
    v_mul_f32 v62, v62, v58
    v_mul_f32 v63, v63, v59
    s_waitcnt lgkmcnt(6)
    v_mfma_f32_32x32x16_bf16 v[24:39], a[96:99], v[40:43], v[24:39]
    ds_read_b128 v[40:43], v108 offset:33536
    v_cvt_pk_bf16_f32 v66, v60, v61
    v_cvt_pk_bf16_f32 v67, v62, v63
    s_add_u32 s93, s12, 0x938000
    buffer_store_dwordx4 v[64:67], v68, s[76:79], s93 offen sc1
    s_add_u32 m0, s9, 3072
    s_add_u32 s90, s8, 221184
    buffer_load_dwordx4 v113, s[64:67], s90 offen lds
    s_waitcnt lgkmcnt(4)
    v_mfma_f32_32x32x16_bf16 v[24:39], a[100:103], v[44:47], v[24:39]
    ds_read_b128 v[44:47], v109 offset:33536
    s_waitcnt vmcnt(5)
    v_cmp_ne_u32 vcc, s88, v71
    s_nop 4
    s_cbranch_vccnz L_retry_66
L_back_65:
    s_waitcnt lgkmcnt(3)
    v_mfma_f32_32x32x16_bf16 v[24:39], a[104:107], v[48:51], v[24:39]
    ds_read_b128 v[48:51], v110 offset:33536
    buffer_load_dwordx4 a[80:83], v7, s[76:79], s16 offen offset:0 sc1
    s_waitcnt lgkmcnt(3)
    v_mfma_f32_32x32x16_bf16 v[24:39], a[108:111], v[52:55], v[24:39]
    ds_read_b128 v[52:55], v111 offset:33536
    v_max_u32 v71, v120, v121
    v_max3_u32 v71, v71, v122, v123
    v_cmp_eq_u32 vcc, -1, v71
    s_nop 4
    s_cbranch_vccnz L_retry_70
L_back_69:
    s_waitcnt lgkmcnt(3)
    v_mfma_f32_32x32x16_bf16 v[24:39], a[112:115], v[40:43], v[24:39]
    buffer_load_dwordx4 a[84:87], v7, s[76:79], s16 offen offset:1024 sc1
    s_waitcnt lgkmcnt(2)
    v_mfma_f32_32x32x16_bf16 v[24:39], a[116:119], v[44:47], v[24:39]
    ds_read_b64_tr_b16 a[48:49], v114 offset:8192
    s_waitcnt lgkmcnt(2)
    v_mfma_f32_32x32x16_bf16 v[24:39], a[120:123], v[48:51], v[24:39]
    buffer_load_dwordx4 a[88:91], v7, s[76:79], s16 offen offset:2048 sc1
    ds_read_b64_tr_b16 a[50:51], v114 offset:8704
    ds_read_b64_tr_b16 a[52:53], v115 offset:8192
    s_waitcnt lgkmcnt(3)
    v_mfma_f32_32x32x16_bf16 v[24:39], a[124:127], v[52:55], v[24:39]
    ds_read_b64_tr_b16 a[54:55], v115 offset:8704
    ds_read_b64_tr_b16 a[56:57], v116 offset:8192
    s_mov_b32 s91, 0xe8000
    buffer_load_dword v71, v119, s[76:79], s91 offen sc1
    ds_read_b64_tr_b16 a[58:59], v116 offset:8704
    ds_read_b64_tr_b16 a[60:61], v117 offset:8192
    ds_read_b64_tr_b16 a[62:63], v117 offset:8704
    s_nop 4
    v_mul_f32 v56, v24, v24
    v_mul_f32 v57, v25, v25
    v_mul_f32 v58, v26, v26
    v_mul_f32 v59, v27, v27
    v_fma_f32 v56, v56, v70, v69
    v_fma_f32 v57, v57, v70, v69
    v_fma_f32 v58, v58, v70, v69
    v_fma_f32 v59, v59, v70, v69
    v_mul_f32 v56, v56, v24
    v_mul_f32 v57, v57, v25
    buffer_load_dwordx4 a[92:95], v7, s[76:79], s16 offen offset:3072 sc1
    v_mul_f32 v58, v58, v26
    v_mul_f32 v59, v59, v27
    v_exp_f32 v56, v56
    v_mul_f32 v60, v24, v32
    v_exp_f32 v57, v57
    v_mul_f32 v61, v25, v33
    v_exp_f32 v58, v58
    v_mul_f32 v62, v26, v34
    v_exp_f32 v59, v59
    v_mul_f32 v63, v27, v35
    buffer_load_dwordx4 a[96:99], v7, s[76:79], s17 offen offset:0 sc1
    v_add_f32 v56, 1.0, v56
    v_add_f32 v57, 1.0, v57
    v_add_f32 v58, 1.0, v58
    v_add_f32 v59, 1.0, v59
    v_rcp_f32 v56, v56
    v_rcp_f32 v57, v57
    v_rcp_f32 v58, v58
    v_rcp_f32 v59, v59
    v_mul_f32 v60, v60, v56
    v_mul_f32 v61, v61, v57
    buffer_load_dwordx4 a[100:103], v7, s[76:79], s17 offen offset:1024 sc1
    v_mul_f32 v62, v62, v58
    v_mul_f32 v63, v63, v59
    v_cvt_pk_bf16_f32 v64, v60, v61
    v_cvt_pk_bf16_f32 v65, v62, v63
    v_mul_f32 v56, v28, v28
    v_mul_f32 v57, v29, v29
    v_mul_f32 v58, v30, v30
    v_mul_f32 v59, v31, v31
    v_fma_f32 v56, v56, v70, v69
    v_fma_f32 v57, v57, v70, v69
    buffer_load_dwordx4 a[104:107], v7, s[76:79], s17 offen offset:2048 sc1
    v_fma_f32 v58, v58, v70, v69
    v_fma_f32 v59, v59, v70, v69
    v_mul_f32 v56, v56, v28
    v_mul_f32 v57, v57, v29
    v_mul_f32 v58, v58, v30
    v_mul_f32 v59, v59, v31
    v_exp_f32 v56, v56
    v_mul_f32 v60, v28, v36
    v_exp_f32 v57, v57
    v_mul_f32 v61, v29, v37
    v_exp_f32 v58, v58
    v_mul_f32 v62, v30, v38
    v_exp_f32 v59, v59
    v_mul_f32 v63, v31, v39
    v_add_f32 v56, 1.0, v56
    v_add_f32 v57, 1.0, v57
    v_add_f32 v58, 1.0, v58
    v_add_f32 v59, 1.0, v59
    v_rcp_f32 v56, v56
    v_rcp_f32 v57, v57
    v_rcp_f32 v58, v58
    v_rcp_f32 v59, v59
    v_mul_f32 v60, v60, v56
    v_mul_f32 v61, v61, v57
    v_mul_f32 v62, v62, v58
    v_mul_f32 v63, v63, v59
    v_cvt_pk_bf16_f32 v66, v60, v61
    v_cvt_pk_bf16_f32 v67, v62, v63
    s_add_u32 s93, s12, 0x954000
    buffer_store_dwordx4 v[64:67], v68, s[76:79], s93 offen sc1
    s_waitcnt vmcnt(9)
    ds_read_b64_tr_b16 a[64:65], v114 offset:0
    ds_read_b64_tr_b16 a[66:67], v114 offset:512
    ds_read_b64_tr_b16 a[68:69], v115 offset:0
    ds_read_b64_tr_b16 a[70:71], v115 offset:512
    ds_read_b64_tr_b16 a[72:73], v116 offset:0
    ds_read_b64_tr_b16 a[74:75], v116 offset:512
    ds_read_b64_tr_b16 a[76:77], v117 offset:0
    ds_read_b64_tr_b16 a[78:79], v117 offset:512
    s_setprio 0
L_g1j_48:
    s_waitcnt lgkmcnt(0)
    s_waitcnt vmcnt(8)
    v_mfma_f32_16x16x32_bf16 v[8:11], v[72:75], a[80:83], 0
    s_barrier
    s_add_u32 s92, s6, 0xf0000
    s_mov_b32 exec_lo, 0xffff
    s_mov_b32 exec_hi, 0
    buffer_store_dword v126, v0, s[76:79], s92 offen sc1
    s_mov_b64 exec, -1
    s_waitcnt vmcnt(6)
    v_cmp_ne_u32 vcc, s88, v71
    s_nop 4
    s_cbranch_vccnz L_retry_82
L_back_81:
    buffer_load_dwordx4 a[108:111], v7, s[76:79], s18 offen offset:0 sc1
    v_and_b32 v4, 15, v1
    v_mfma_f32_16x16x32_bf16 v[12:15], v[76:79], a[80:83], 0
    v_mul_u32_u24 v5, 144, v4
    v_mfma_f32_16x16x32_bf16 v[16:19], v[80:83], a[80:83], 0
    v_lshrrev_b32 v6, 4, v1
    v_mfma_f32_16x16x32_bf16 v[20:23], v[84:87], a[80:83], 0
    v_lshl_add_u32 v5, v6, 4, v5
    v_mfma_f32_16x16x32_bf16 v[8:11], v[88:91], a[84:87], v[8:11]
    buffer_load_dwordx4 a[112:115], v7, s[76:79], s18 offen offset:1024 sc1
    v_add_u32 v111, s9, v5
    v_mfma_f32_16x16x32_bf16 v[12:15], v[92:95], a[84:87], v[12:15]
    v_mul_u32_u24 v6, 12288, v6
    v_mfma_f32_16x16x32_bf16 v[16:19], v[96:99], a[84:87], v[16:19]
    v_lshrrev_b32 v5, 3, v4
    v_mfma_f32_16x16x32_bf16 v[20:23], v[100:103], a[84:87], v[20:23]
    v_lshl_add_u32 v5, s84, 1, v5
    v_mfma_f32_16x16x32_bf16 v[8:11], a[0:3], a[88:91], v[8:11]
    buffer_load_dwordx4 a[116:119], v7, s[76:79], s18 offen offset:2048 sc1
    v_mul_u32_u24 v5, 144, v5
    v_mfma_f32_16x16x32_bf16 v[12:15], a[4:7], a[88:91], v[12:15]
    v_add_u32 v6, v6, v5
    v_mfma_f32_16x16x32_bf16 v[16:19], a[8:11], a[88:91], v[16:19]
    v_and_b32 v5, 7, v4
    v_mfma_f32_16x16x32_bf16 v[20:23], a[12:15], a[88:91], v[20:23]
    v_lshl_add_u32 v6, v5, 4, v6
    s_waitcnt vmcnt(8)
    v_mfma_f32_16x16x32_bf16 v[8:11], a[16:19], a[92:95], v[8:11]
    buffer_load_dwordx4 a[120:123], v7, s[76:79], s18 offen offset:3072 sc1
    v_add_u32 v110, 65536, v6
    v_mfma_f32_16x16x32_bf16 v[12:15], a[20:23], a[92:95], v[12:15]
    v_and_b32 v5, 1, v4
    v_mfma_f32_16x16x32_bf16 v[16:19], a[24:27], a[92:95], v[16:19]
    v_lshlrev_b32 v5, 4, v5
    v_mfma_f32_16x16x32_bf16 v[20:23], a[28:31], a[92:95], v[20:23]
    v_mov_b32 v6, 0x3f80
    s_waitcnt vmcnt(8)
    v_mfma_f32_16x16x32_bf16 v[8:11], a[32:35], a[96:99], v[8:11]
    buffer_load_dwordx4 a[124:127], v7, s[76:79], s19 offen offset:0 sc1
    v_lshlrev_b32 v5, v5, v6
    v_mfma_f32_16x16x32_bf16 v[12:15], a[36:39], a[96:99], v[12:15]
    v_bfe_u32 v4, v4, 1, 2
    v_mfma_f32_16x16x32_bf16 v[16:19], a[40:43], a[96:99], v[16:19]
    s_mov_b32 s14, 0
    v_mfma_f32_16x16x32_bf16 v[20:23], a[44:47], a[96:99], v[20:23]
    s_mov_b32 s15, -1
    s_waitcnt vmcnt(8)
    v_mfma_f32_16x16x32_bf16 v[8:11], a[48:51], a[100:103], v[8:11]
    s_waitcnt vmcnt(6)
    s_barrier
    s_add_u32 s92, s6, 0xf8000
    s_mov_b32 exec_lo, 0xffff
    s_mov_b32 exec_hi, 0
    buffer_store_dword v126, v0, s[76:79], s92 offen sc1
    s_mov_b64 exec, -1
    buffer_load_dwordx4 a[80:83], v7, s[76:79], s19 offen offset:1024 sc1
    v_cmp_eq_u32 vcc, 0, v4
    s_nop 1
    v_cndmask_b32 v56, 0, v5, vcc
    v_mfma_f32_16x16x32_bf16 v[12:15], a[52:55], a[100:103], v[12:15]
    s_mov_b32 s91, 0xf0000
    buffer_load_dword v71, v119, s[76:79], s91 offen sc1
    v_cmp_eq_u32 vcc, 1, v4
    s_nop 1
    v_cndmask_b32 v57, 0, v5, vcc
    v_mfma_f32_16x16x32_bf16 v[16:19], a[56:59], a[100:103], v[16:19]
    v_cmp_eq_u32 vcc, 2, v4
    s_nop 1
    v_cndmask_b32 v58, 0, v5, vcc
    v_mfma_f32_16x16x32_bf16 v[20:23], a[60:63], a[100:103], v[20:23]
    v_cmp_eq_u32 vcc, 3, v4
    s_nop 1
    v_cndmask_b32 v59, 0, v5, vcc
    v_mfma_f32_16x16x32_bf16 v[8:11], a[64:67], a[104:107], v[8:11]
    buffer_load_dwordx4 a[84:87], v7, s[76:79], s19 offen offset:2048 sc1
    v_mfma_f32_16x16x32_bf16 v[12:15], a[68:71], a[104:107], v[12:15]
    v_mfma_f32_16x16x32_bf16 v[16:19], a[72:75], a[104:107], v[16:19]
    v_mfma_f32_16x16x32_bf16 v[20:23], a[76:79], a[104:107], v[20:23]
    s_waitcnt vmcnt(8)
    v_mfma_f32_16x16x32_bf16 v[40:43], v[72:75], a[108:111], 0
    v_mfma_f32_16x16x32_bf16 v[44:47], v[76:79], a[108:111], 0
    v_mfma_f32_16x16x32_bf16 v[48:51], v[80:83], a[108:111], 0
    v_cvt_pk_bf16_f32 v24, v8, v9
    v_mfma_f32_16x16x32_bf16 v[52:55], v[84:87], a[108:111], 0
    v_cvt_pk_bf16_f32 v25, v10, v11
    s_waitcnt vmcnt(7)
    v_mfma_f32_16x16x32_bf16 v[40:43], v[88:91], a[112:115], v[40:43]
    v_cvt_pk_bf16_f32 v26, v16, v17
    v_mfma_f32_16x16x32_bf16 v[44:47], v[92:95], a[112:115], v[44:47]
    v_cvt_pk_bf16_f32 v27, v18, v19
    v_mfma_f32_16x16x32_bf16 v[48:51], v[96:99], a[112:115], v[48:51]
    ds_write_b128 v111, v[24:27] offset:0
    v_mfma_f32_16x16x32_bf16 v[52:55], v[100:103], a[112:115], v[52:55]
    v_cvt_pk_bf16_f32 v28, v12, v13
    s_waitcnt vmcnt(6)
    v_mfma_f32_16x16x32_bf16 v[40:43], a[0:3], a[116:119], v[40:43]
    s_waitcnt vmcnt(1)
    v_cmp_ne_u32 vcc, s88, v71
    s_nop 4
    s_cbranch_vccnz L_retry_86
L_back_85:
    buffer_load_dwordx4 a[88:91], v7, s[76:79], s20 offen offset:0 sc1
    v_cvt_pk_bf16_f32 v29, v14, v15
    v_mfma_f32_16x16x32_bf16 v[44:47], a[4:7], a[116:119], v[44:47]
    v_cvt_pk_bf16_f32 v30, v20, v21
    v_mfma_f32_16x16x32_bf16 v[48:51], a[8:11], a[116:119], v[48:51]
    buffer_load_dwordx4 a[92:95], v7, s[76:79], s20 offen offset:1024 sc1
    v_cvt_pk_bf16_f32 v31, v22, v23
    v_mfma_f32_16x16x32_bf16 v[52:55], a[12:15], a[116:119], v[52:55]
    ds_write_b128 v111, v[28:31] offset:64
    v_mfma_f32_16x16x32_bf16 v[40:43], a[16:19], a[120:123], v[40:43]
    buffer_load_dwordx4 a[96:99], v7, s[76:79], s20 offen offset:2048 sc1
    v_mfma_f32_16x16x32_bf16 v[44:47], a[20:23], a[120:123], v[44:47]
    v_mfma_f32_16x16x32_bf16 v[48:51], a[24:27], a[120:123], v[48:51]
    buffer_load_dwordx4 a[100:103], v7, s[76:79], s20 offen offset:3072 sc1
    v_mfma_f32_16x16x32_bf16 v[52:55], a[28:31], a[120:123], v[52:55]
    v_mfma_f32_16x16x32_bf16 v[40:43], a[32:35], a[124:127], v[40:43]
    buffer_load_dwordx4 a[104:107], v7, s[76:79], s21 offen offset:0 sc1
    v_mfma_f32_16x16x32_bf16 v[44:47], a[36:39], a[124:127], v[44:47]
    v_mfma_f32_16x16x32_bf16 v[48:51], a[40:43], a[124:127], v[48:51]
    v_mfma_f32_16x16x32_bf16 v[52:55], a[44:47], a[124:127], v[52:55]
    v_mfma_f32_16x16x32_bf16 v[40:43], a[48:51], a[80:83], v[40:43]
    buffer_load_dwordx4 a[108:111], v7, s[76:79], s21 offen offset:1024 sc1
    v_mfma_f32_16x16x32_bf16 v[44:47], a[52:55], a[80:83], v[44:47]
    s_mov_b32 s91, 0xf8000
    buffer_load_dword v71, v119, s[76:79], s91 offen sc1
    v_mfma_f32_16x16x32_bf16 v[48:51], a[56:59], a[80:83], v[48:51]
    v_mfma_f32_16x16x32_bf16 v[52:55], a[60:63], a[80:83], v[52:55]
    s_waitcnt vmcnt(7)
    v_mfma_f32_16x16x32_bf16 v[40:43], a[64:67], a[84:87], v[40:43]
    buffer_load_dwordx4 a[112:115], v7, s[76:79], s21 offen offset:2048 sc1
    v_mfma_f32_16x16x32_bf16 v[44:47], a[68:71], a[84:87], v[44:47]
    v_mfma_f32_16x16x32_bf16 v[48:51], a[72:75], a[84:87], v[48:51]
    v_mfma_f32_16x16x32_bf16 v[52:55], a[76:79], a[84:87], v[52:55]
    s_waitcnt vmcnt(7)
    v_mfma_f32_16x16x32_bf16 v[8:11], v[72:75], a[88:91], 0
    s_waitcnt vmcnt(1)
    v_cmp_ne_u32 vcc, s88, v71
    s_nop 4
    s_cbranch_vccnz L_retry_90
L_back_89:
    buffer_load_dwordx4 a[116:119], v7, s[76:79], s22 offen offset:0 sc1
    v_mfma_f32_16x16x32_bf16 v[12:15], v[76:79], a[88:91], 0
    v_mfma_f32_16x16x32_bf16 v[16:19], v[80:83], a[88:91], 0
    v_cvt_pk_bf16_f32 v24, v40, v41
    v_mfma_f32_16x16x32_bf16 v[20:23], v[84:87], a[88:91], 0
    v_cvt_pk_bf16_f32 v25, v42, v43
    v_mfma_f32_16x16x32_bf16 v[8:11], v[88:91], a[92:95], v[8:11]
    buffer_load_dwordx4 a[120:123], v7, s[76:79], s22 offen offset:1024 sc1
    v_cvt_pk_bf16_f32 v26, v48, v49
    v_mfma_f32_16x16x32_bf16 v[12:15], v[92:95], a[92:95], v[12:15]
    v_cvt_pk_bf16_f32 v27, v50, v51
    v_mfma_f32_16x16x32_bf16 v[16:19], v[96:99], a[92:95], v[16:19]
    ds_write_b128 v111, v[24:27] offset:2304
    v_mfma_f32_16x16x32_bf16 v[20:23], v[100:103], a[92:95], v[20:23]
    v_cvt_pk_bf16_f32 v28, v44, v45
    v_mfma_f32_16x16x32_bf16 v[8:11], a[0:3], a[96:99], v[8:11]
    buffer_load_dwordx4 a[124:127], v7, s[76:79], s22 offen offset:2048 sc1
    v_cvt_pk_bf16_f32 v29, v46, v47
    v_mfma_f32_16x16x32_bf16 v[12:15], a[4:7], a[96:99], v[12:15]
    v_cvt_pk_bf16_f32 v30, v52, v53
    v_mfma_f32_16x16x32_bf16 v[16:19], a[8:11], a[96:99], v[16:19]
    v_cvt_pk_bf16_f32 v31, v54, v55
    v_mfma_f32_16x16x32_bf16 v[20:23], a[12:15], a[96:99], v[20:23]
    ds_write_b128 v111, v[28:31] offset:2368
    v_mfma_f32_16x16x32_bf16 v[8:11], a[16:19], a[100:103], v[8:11]
    buffer_load_dwordx4 a[80:83], v7, s[76:79], s22 offen offset:3072 sc1
    v_mfma_f32_16x16x32_bf16 v[12:15], a[20:23], a[100:103], v[12:15]
    v_mfma_f32_16x16x32_bf16 v[16:19], a[24:27], a[100:103], v[16:19]
    v_mfma_f32_16x16x32_bf16 v[20:23], a[28:31], a[100:103], v[20:23]
    v_mfma_f32_16x16x32_bf16 v[8:11], a[32:35], a[104:107], v[8:11]
    buffer_load_dwordx4 a[84:87], v7, s[76:79], s23 offen offset:0 sc1
    v_mfma_f32_16x16x32_bf16 v[12:15], a[36:39], a[104:107], v[12:15]
    v_mfma_f32_16x16x32_bf16 v[16:19], a[40:43], a[104:107], v[16:19]
    v_mfma_f32_16x16x32_bf16 v[20:23], a[44:47], a[104:107], v[20:23]
    v_mfma_f32_16x16x32_bf16 v[8:11], a[48:51], a[108:111], v[8:11]
    s_waitcnt lgkmcnt(0)
    s_barrier
    ds_read_b128 v[32:35], v110 offset:0
    ds_read_b128 v[36:39], v110 offset:2304
    ds_read_b128 v[104:107], v110 offset:49152
    ds_read_b128 v[112:115], v110 offset:51456
    buffer_load_dwordx4 a[88:91], v7, s[76:79], s23 offen offset:1024 sc1
    v_mfma_f32_16x16x32_bf16 v[12:15], a[52:55], a[108:111], v[12:15]
    v_mfma_f32_16x16x32_bf16 v[16:19], a[56:59], a[108:111], v[16:19]
    v_mfma_f32_16x16x32_bf16 v[20:23], a[60:63], a[108:111], v[20:23]
    s_waitcnt vmcnt(6)
    v_mfma_f32_16x16x32_bf16 v[8:11], a[64:67], a[112:115], v[8:11]
    buffer_load_dwordx4 a[92:95], v7, s[76:79], s23 offen offset:2048 sc1
    s_waitcnt lgkmcnt(3)
    v_mfma_f32_16x16x32_bf16 v[64:67], v[56:59], v[32:35], 0
    v_mfma_f32_16x16x32_bf16 v[12:15], a[68:71], a[112:115], v[12:15]
    s_waitcnt lgkmcnt(2)
    v_mfma_f32_16x16x32_bf16 v[60:63], v[56:59], v[36:39], 0
    v_mfma_f32_16x16x32_bf16 v[16:19], a[72:75], a[112:115], v[16:19]
    s_waitcnt lgkmcnt(1)
    v_mfma_f32_16x16x32_bf16 v[64:67], v[56:59], v[104:107], v[64:67]
    v_mfma_f32_16x16x32_bf16 v[20:23], a[76:79], a[112:115], v[20:23]
    s_waitcnt lgkmcnt(0)
    v_mfma_f32_16x16x32_bf16 v[60:63], v[56:59], v[112:115], v[60:63]
    s_waitcnt vmcnt(6)
    v_mfma_f32_16x16x32_bf16 v[40:43], v[72:75], a[116:119], 0
    v_and_b32 v33, 0xffff0000, v2
    v_mfma_f32_16x16x32_bf16 v[44:47], v[76:79], a[116:119], 0
    v_lshlrev_b32 v32, 16, v2
    v_mfma_f32_16x16x32_bf16 v[48:51], v[80:83], a[116:119], 0
    v_cvt_pk_bf16_f32 v24, v8, v9
    v_mfma_f32_16x16x32_bf16 v[52:55], v[84:87], a[116:119], 0
    v_cvt_pk_bf16_f32 v25, v10, v11
    s_waitcnt vmcnt(5)
    v_mfma_f32_16x16x32_bf16 v[40:43], v[88:91], a[120:123], v[40:43]
    v_cvt_pk_bf16_f32 v26, v16, v17
    v_mfma_f32_16x16x32_bf16 v[44:47], v[92:95], a[120:123], v[44:47]
    v_cvt_pk_bf16_f32 v27, v18, v19
    v_mfma_f32_16x16x32_bf16 v[48:51], v[96:99], a[120:123], v[48:51]
    ds_write_b128 v111, v[24:27] offset:4608
    v_mfma_f32_16x16x32_bf16 v[52:55], v[100:103], a[120:123], v[52:55]
    v_cvt_pk_bf16_f32 v28, v12, v13
    s_waitcnt vmcnt(4)
    v_mfma_f32_16x16x32_bf16 v[40:43], a[0:3], a[124:127], v[40:43]
    v_cvt_pk_bf16_f32 v29, v14, v15
    v_mfma_f32_16x16x32_bf16 v[44:47], a[4:7], a[124:127], v[44:47]
    v_cvt_pk_bf16_f32 v30, v20, v21
    v_mfma_f32_16x16x32_bf16 v[48:51], a[8:11], a[124:127], v[48:51]
    v_cvt_pk_bf16_f32 v31, v22, v23
    v_mfma_f32_16x16x32_bf16 v[52:55], a[12:15], a[124:127], v[52:55]
    ds_write_b128 v111, v[28:31] offset:4672
    s_waitcnt vmcnt(3)
    v_mfma_f32_16x16x32_bf16 v[40:43], a[16:19], a[80:83], v[40:43]
    v_and_b32 v35, 0xffff0000, v3
    v_mfma_f32_16x16x32_bf16 v[44:47], a[20:23], a[80:83], v[44:47]
    v_lshlrev_b32 v34, 16, v3
    v_mfma_f32_16x16x32_bf16 v[48:51], a[24:27], a[80:83], v[48:51]
    v_cndmask_b32 v64, v64, v60, s[14:15]
    v_mfma_f32_16x16x32_bf16 v[52:55], a[28:31], a[80:83], v[52:55]
    v_cndmask_b32 v65, v65, v61, s[14:15]
    s_waitcnt vmcnt(2)
    v_mfma_f32_16x16x32_bf16 v[40:43], a[32:35], a[84:87], v[40:43]
    v_cndmask_b32 v66, v66, v62, s[14:15]
    v_mfma_f32_16x16x32_bf16 v[44:47], a[36:39], a[84:87], v[44:47]
    v_cndmask_b32 v67, v67, v63, s[14:15]
    v_mfma_f32_16x16x32_bf16 v[48:51], a[40:43], a[84:87], v[48:51]
    v_fma_f32 v32, v64, v120, v32
    v_mfma_f32_16x16x32_bf16 v[52:55], a[44:47], a[84:87], v[52:55]
    v_fma_f32 v33, v65, v121, v33
    s_waitcnt vmcnt(1)
    v_mfma_f32_16x16x32_bf16 v[40:43], a[48:51], a[88:91], v[40:43]
    v_fma_f32 v34, v66, v122, v34
    v_mfma_f32_16x16x32_bf16 v[44:47], a[52:55], a[88:91], v[44:47]
    v_fma_f32 v35, v67, v123, v35
    v_mfma_f32_16x16x32_bf16 v[48:51], a[56:59], a[88:91], v[48:51]
    v_cvt_pk_bf16_f32 v2, v32, v33
    v_mfma_f32_16x16x32_bf16 v[52:55], a[60:63], a[88:91], v[52:55]
    v_cvt_pk_bf16_f32 v3, v34, v35
    s_waitcnt vmcnt(0)
    v_mfma_f32_16x16x32_bf16 v[40:43], a[64:67], a[92:95], v[40:43]
    v_mfma_f32_16x16x32_bf16 v[44:47], a[68:71], a[92:95], v[44:47]
    v_mfma_f32_16x16x32_bf16 v[48:51], a[72:75], a[92:95], v[48:51]
    v_mfma_f32_16x16x32_bf16 v[52:55], a[76:79], a[92:95], v[52:55]
    s_mov_b32 s92, 0
    buffer_store_dwordx2 v[2:3], v118, s[72:75], s92 offen sc1
    s_nop 2
    v_cvt_pk_bf16_f32 v24, v40, v41
    v_cvt_pk_bf16_f32 v25, v42, v43
    v_cvt_pk_bf16_f32 v26, v48, v49
    v_cvt_pk_bf16_f32 v27, v50, v51
    ds_write_b128 v111, v[24:27] offset:6912
    v_cvt_pk_bf16_f32 v28, v44, v45
    v_cvt_pk_bf16_f32 v29, v46, v47
    v_cvt_pk_bf16_f32 v30, v52, v53
    v_cvt_pk_bf16_f32 v31, v54, v55
    ds_write_b128 v111, v[28:31] offset:6976
    s_waitcnt lgkmcnt(0)
    s_barrier
    ds_read_b128 v[32:35], v110 offset:4608
    ds_read_b128 v[36:39], v110 offset:6912
    ds_read_b128 v[104:107], v110 offset:53760
    ds_read_b128 v[112:115], v110 offset:56064
    s_waitcnt lgkmcnt(3)
    v_mfma_f32_16x16x32_bf16 v[64:67], v[56:59], v[32:35], 0
    s_waitcnt lgkmcnt(2)
    v_mfma_f32_16x16x32_bf16 v[60:63], v[56:59], v[36:39], 0
    s_waitcnt lgkmcnt(1)
    v_mfma_f32_16x16x32_bf16 v[64:67], v[56:59], v[104:107], v[64:67]
    s_waitcnt lgkmcnt(0)
    v_mfma_f32_16x16x32_bf16 v[60:63], v[56:59], v[112:115], v[60:63]
    v_and_b32 v33, 0xffff0000, v124
    v_lshlrev_b32 v32, 16, v124
    v_and_b32 v35, 0xffff0000, v125
    v_lshlrev_b32 v34, 16, v125
    s_nop 3
    v_cndmask_b32 v64, v64, v60, s[14:15]
    v_cndmask_b32 v65, v65, v61, s[14:15]
    v_cndmask_b32 v66, v66, v62, s[14:15]
    v_cndmask_b32 v67, v67, v63, s[14:15]
    v_fma_f32 v32, v64, v120, v32
    v_fma_f32 v33, v65, v121, v33
    v_fma_f32 v34, v66, v122, v34
    v_fma_f32 v35, v67, v123, v35
    v_cvt_pk_bf16_f32 v124, v32, v33
    v_cvt_pk_bf16_f32 v125, v34, v35
    s_mov_b32 s92, 65536
    buffer_store_dwordx2 v[124:125], v118, s[72:75], s92 offen sc1
L_end:
    s_endpgm
L_retry_18:
    s_mov_b32 s94, 0x8000
L_again_15:
    s_mov_b64 exec, vcc
    buffer_load_dword v125, v4, s[76:79], s91 offen sc1
    s_waitcnt vmcnt(0)
    v_cmp_ne_u32 vcc, s88, v125
    s_nop 4
    s_cbranch_vccz L_arrived_16
    s_sub_u32 s94, s94, 1
    s_cmp_lg_u32 s94, 0
    s_cbranch_scc1 L_again_15
L_arrived_16:
    s_mov_b64 exec, -1
    s_branch L_back_17
L_retry_37:
    s_mov_b32 s94, 0x8000
L_again_34:
    s_mov_b64 exec, vcc
    buffer_load_dword v125, v123, s[76:79], s93 offen sc1
    s_waitcnt vmcnt(0)
    v_cmp_ne_u32 vcc, s88, v125
    s_nop 4
    s_cbranch_vccz L_arrived_35
    s_sub_u32 s94, s94, 1
    s_cmp_lg_u32 s94, 0
    s_cbranch_scc1 L_again_34
L_arrived_35:
    s_mov_b64 exec, -1
    s_branch L_back_36
L_retry_41:
    s_mov_b32 s94, 0x8000
L_again_38:
    s_mov_b64 exec, vcc
    buffer_load_dwordx4 v[60:63], v28, s[76:79], s90 offen offset:0 sc1
    buffer_load_dwordx4 v[52:55], v30, s[76:79], s91 offen offset:0 sc1
    s_waitcnt vmcnt(0)
    v_max_u32 v125, v60, v61
    v_max3_u32 v125, v125, v62, v63
    v_max3_u32 v125, v125, v52, v53
    v_max3_u32 v125, v125, v54, v55
    v_cmp_eq_u32 vcc, -1, v125
    s_nop 4
    s_cbranch_vccz L_arrived_39
    s_sub_u32 s94, s94, 1
    s_cmp_lg_u32 s94, 0
    s_cbranch_scc1 L_again_38
L_arrived_39:
    s_mov_b64 exec, -1
    s_branch L_back_40
L_retry_46:
    s_mov_b32 s94, 0x8000
L_again_43:
    s_mov_b64 exec, vcc
    s_add_u32 m0, s11, 0
    s_add_u32 s93, s10, 0x500000
    buffer_load_dwordx4 v5, s[76:79], s93 offen sc1 lds
    s_add_u32 m0, s11, 8192
    s_add_u32 s93, s10, 0x502000
    buffer_load_dwordx4 v6, s[76:79], s93 offen sc1 lds
    s_add_u32 m0, s11, 16384
    s_add_u32 s93, s10, 0x504000
    buffer_load_dwordx4 v5, s[76:79], s93 offen sc1 lds
    s_add_u32 m0, s11, 24576
    s_add_u32 s93, s10, 0x506000
    buffer_load_dwordx4 v6, s[76:79], s93 offen sc1 lds
    s_waitcnt vmcnt(0)
    ds_read_b128 v[24:27], v2 offset:0
    ds_read_b128 v[28:31], v2 offset:8192
    ds_read_b128 v[32:35], v2 offset:16384
    ds_read_b128 v[36:39], v2 offset:24576
    s_waitcnt lgkmcnt(0)
    v_max_u32 v71, v24, v25
    v_max3_u32 v71, v71, v26, v27
    v_max3_u32 v71, v71, v28, v29
    v_max3_u32 v71, v71, v30, v31
    v_max3_u32 v71, v71, v32, v33
    v_max3_u32 v71, v71, v34, v35
    v_max3_u32 v71, v71, v36, v37
    v_max3_u32 v71, v71, v38, v39
    v_cmp_eq_u32 vcc, -1, v71
    s_nop 4
    s_cbranch_vccz L_arrived_44
    s_sub_u32 s94, s94, 1
    s_cmp_lg_u32 s94, 0
    s_cbranch_scc1 L_again_43
L_arrived_44:
    s_mov_b64 exec, -1
    s_branch L_back_45
L_retry_56:
    s_mov_b32 s94, 0x8000
L_again_53:
    s_mov_b64 exec, vcc
    buffer_load_dword v71, v3, s[76:79], s91 offen sc1
    s_waitcnt vmcnt(0)
    v_cmp_ne_u32 vcc, s88, v71
    s_nop 4
    s_cbranch_vccz L_arrived_54
    s_sub_u32 s94, s94, 1
    s_cmp_lg_u32 s94, 0
    s_cbranch_scc1 L_again_53
L_arrived_54:
    s_mov_b64 exec, -1
    s_branch L_back_55
L_retry_62:
    s_mov_b32 s94, 0x8000
L_again_59:
    s_mov_b64 exec, vcc
    buffer_load_dword v71, v4, s[76:79], s91 offen sc1
    s_waitcnt vmcnt(0)
    v_cmp_ne_u32 vcc, s88, v71
    s_nop 4
    s_cbranch_vccz L_arrived_60
    s_sub_u32 s94, s94, 1
    s_cmp_lg_u32 s94, 0
    s_cbranch_scc1 L_again_59
L_arrived_60:
    s_mov_b64 exec, -1
    s_branch L_back_61
L_retry_66:
    s_mov_b32 s94, 0x8000
L_again_63:
    s_mov_b64 exec, vcc
    buffer_load_dword v71, v119, s[76:79], s91 offen sc1
    s_waitcnt vmcnt(0)
    v_cmp_ne_u32 vcc, s88, v71
    s_nop 4
    s_cbranch_vccz L_arrived_64
    s_sub_u32 s94, s94, 1
    s_cmp_lg_u32 s94, 0
    s_cbranch_scc1 L_again_63
L_arrived_64:
    s_mov_b64 exec, -1
    s_branch L_back_65
L_retry_70:
    s_mov_b32 s94, 0x8000
L_again_67:
    s_mov_b64 exec, vcc
    v_and_b32 v4, 0x3ff, v118
    v_lshlrev_b32 v4, 1, v4
    s_mov_b32 s90, 0x52000
    buffer_load_dwordx4 v[120:123], v4, s[76:79], s90 offen sc1
    s_waitcnt vmcnt(0)
    v_max_u32 v71, v120, v121
    v_max3_u32 v71, v71, v122, v123
    v_cmp_eq_u32 vcc, -1, v71
    s_nop 4
    s_cbranch_vccz L_arrived_68
    s_sub_u32 s94, s94, 1
    s_cmp_lg_u32 s94, 0
    s_cbranch_scc1 L_again_67
L_arrived_68:
    s_mov_b64 exec, -1
    s_branch L_back_69
L_retry_74:
    s_mov_b32 s94, 0x8000
L_again_71:
    s_mov_b64 exec, vcc
    buffer_load_dword v71, v119, s[76:79], s91 offen sc1
    s_waitcnt vmcnt(0)
    v_cmp_ne_u32 vcc, s88, v71
    s_nop 4
    s_cbranch_vccz L_arrived_72
    s_sub_u32 s94, s94, 1
    s_cmp_lg_u32 s94, 0
    s_cbranch_scc1 L_again_71
L_arrived_72:
    s_mov_b64 exec, -1
    s_branch L_back_73
L_retry_78:
    s_mov_b32 s94, 0x8000
L_again_75:
    s_mov_b64 exec, vcc
    v_and_b32 v4, 0x3ff, v118
    v_lshlrev_b32 v4, 1, v4
    s_mov_b32 s90, 0x52000
    buffer_load_dwordx4 v[120:123], v4, s[76:79], s90 offen sc1
    s_waitcnt vmcnt(0)
    v_max_u32 v71, v120, v121
    v_max3_u32 v71, v71, v122, v123
    v_cmp_eq_u32 vcc, -1, v71
    s_nop 4
    s_cbranch_vccz L_arrived_76
    s_sub_u32 s94, s94, 1
    s_cmp_lg_u32 s94, 0
    s_cbranch_scc1 L_again_75
L_arrived_76:
    s_mov_b64 exec, -1
    s_branch L_back_77
L_spare_47:
    s_lshl_b32 s90, s85, 2
    s_add_u32 s90, s90, s86
    s_sub_u32 s90, s90, 28
    s_mul_i32 s90, s90, 57344
    s_mul_i32 s91, s84, 28
    s_add_u32 s91, s91, s86
    s_sub_u32 s91, s91, 28
    s_lshl_b32 s91, s91, 13
    s_waitcnt vmcnt(0)
    s_barrier
    s_add_u32 m0, s9, 0
    s_add_u32 s90, s8, 0
    buffer_load_dwordx4 v112, s[64:67], s90 offen lds
    s_add_u32 m0, s9, 1024
    s_add_u32 s90, s8, 8192
    buffer_load_dwordx4 v113, s[64:67], s90 offen lds
    s_add_u32 m0, s9, 2048
    s_add_u32 s90, s8, 16384
    buffer_load_dwordx4 v112, s[64:67], s90 offen lds
    s_add_u32 m0, s9, 3072
    s_add_u32 s90, s8, 24576
    buffer_load_dwordx4 v113, s[64:67], s90 offen lds
    s_add_u32 m0, s9, 4096
    s_add_u32 s90, s8, 32768
    buffer_load_dwordx4 v112, s[64:67], s90 offen lds
    s_add_u32 m0, s9, 5120
    s_add_u32 s90, s8, 40960
    buffer_load_dwordx4 v113, s[64:67], s90 offen lds
    s_add_u32 m0, s9, 6144
    s_add_u32 s90, s8, 49152
    buffer_load_dwordx4 v112, s[64:67], s90 offen lds
    s_add_u32 m0, s9, 7168
    s_add_u32 s90, s8, 57344
    buffer_load_dwordx4 v113, s[64:67], s90 offen lds
    s_add_u32 m0, s9, 8192
    s_add_u32 s90, s8, 65536
    buffer_load_dwordx4 v112, s[64:67], s90 offen lds
    s_add_u32 m0, s9, 9216
    s_add_u32 s90, s8, 73728
    buffer_load_dwordx4 v113, s[64:67], s90 offen lds
    s_add_u32 m0, s9, 10240
    s_add_u32 s90, s8, 81920
    buffer_load_dwordx4 v112, s[64:67], s90 offen lds
    s_add_u32 m0, s9, 11264
    s_add_u32 s90, s8, 90112
    buffer_load_dwordx4 v113, s[64:67], s90 offen lds
    s_waitcnt vmcnt(8)
    ds_read_b64_tr_b16 v[72:73], v114 offset:0
    ds_read_b64_tr_b16 v[74:75], v114 offset:512
    ds_read_b64_tr_b16 v[76:77], v115 offset:0
    ds_read_b64_tr_b16 v[78:79], v115 offset:512
    ds_read_b64_tr_b16 v[80:81], v116 offset:0
    ds_read_b64_tr_b16 v[82:83], v116 offset:512
    ds_read_b64_tr_b16 v[84:85], v117 offset:0
    ds_read_b64_tr_b16 v[86:87], v117 offset:512
    s_waitcnt vmcnt(4)
    ds_read_b64_tr_b16 v[88:89], v114 offset:4096
    ds_read_b64_tr_b16 v[90:91], v114 offset:4608
    ds_read_b64_tr_b16 v[92:93], v115 offset:4096
    ds_read_b64_tr_b16 v[94:95], v115 offset:4608
    ds_read_b64_tr_b16 v[96:97], v116 offset:4096
    ds_read_b64_tr_b16 v[98:99], v116 offset:4608
    ds_read_b64_tr_b16 v[100:101], v117 offset:4096
    ds_read_b64_tr_b16 v[102:103], v117 offset:4608
    s_waitcnt vmcnt(0)
    ds_read_b64_tr_b16 a[0:1], v114 offset:8192
    ds_read_b64_tr_b16 a[2:3], v114 offset:8704
    ds_read_b64_tr_b16 a[4:5], v115 offset:8192
    ds_read_b64_tr_b16 a[6:7], v115 offset:8704
    ds_read_b64_tr_b16 a[8:9], v116 offset:8192
    ds_read_b64_tr_b16 a[10:11], v116 offset:8704
    ds_read_b64_tr_b16 a[12:13], v117 offset:8192
    ds_read_b64_tr_b16 a[14:15], v117 offset:8704
    s_waitcnt lgkmcnt(0)
    s_add_u32 m0, s9, 0
    s_add_u32 s90, s8, 98304
    buffer_load_dwordx4 v112, s[64:67], s90 offen lds
    s_add_u32 m0, s9, 1024
    s_add_u32 s90, s8, 106496
    buffer_load_dwordx4 v113, s[64:67], s90 offen lds
    s_add_u32 m0, s9, 2048
    s_add_u32 s90, s8, 114688
    buffer_load_dwordx4 v112, s[64:67], s90 offen lds
    s_add_u32 m0, s9, 3072
    s_add_u32 s90, s8, 122880
    buffer_load_dwordx4 v113, s[64:67], s90 offen lds
    s_add_u32 m0, s9, 4096
    s_add_u32 s90, s8, 131072
    buffer_load_dwordx4 v112, s[64:67], s90 offen lds
    s_add_u32 m0, s9, 5120
    s_add_u32 s90, s8, 139264
    buffer_load_dwordx4 v113, s[64:67], s90 offen lds
    s_add_u32 m0, s9, 6144
    s_add_u32 s90, s8, 147456
    buffer_load_dwordx4 v112, s[64:67], s90 offen lds
    s_add_u32 m0, s9, 7168
    s_add_u32 s90, s8, 155648
    buffer_load_dwordx4 v113, s[64:67], s90 offen lds
    s_add_u32 m0, s9, 8192
    s_add_u32 s90, s8, 163840
    buffer_load_dwordx4 v112, s[64:67], s90 offen lds
    s_add_u32 m0, s9, 9216
    s_add_u32 s90, s8, 172032
    buffer_load_dwordx4 v113, s[64:67], s90 offen lds
    s_add_u32 m0, s9, 10240
    s_add_u32 s90, s8, 180224
    buffer_load_dwordx4 v112, s[64:67], s90 offen lds
    s_add_u32 m0, s9, 11264
    s_add_u32 s90, s8, 188416
    buffer_load_dwordx4 v113, s[64:67], s90 offen lds
    s_waitcnt vmcnt(8)
    ds_read_b64_tr_b16 a[16:17], v114 offset:0
    ds_read_b64_tr_b16 a[18:19], v114 offset:512
    ds_read_b64_tr_b16 a[20:21], v115 offset:0
    ds_read_b64_tr_b16 a[22:23], v115 offset:512
    ds_read_b64_tr_b16 a[24:25], v116 offset:0
    ds_read_b64_tr_b16 a[26:27], v116 offset:512
    ds_read_b64_tr_b16 a[28:29], v117 offset:0
    ds_read_b64_tr_b16 a[30:31], v117 offset:512
    s_waitcnt vmcnt(4)
    ds_read_b64_tr_b16 a[32:33], v114 offset:4096
    ds_read_b64_tr_b16 a[34:35], v114 offset:4608
    ds_read_b64_tr_b16 a[36:37], v115 offset:4096
    ds_read_b64_tr_b16 a[38:39], v115 offset:4608
    ds_read_b64_tr_b16 a[40:41], v116 offset:4096
    ds_read_b64_tr_b16 a[42:43], v116 offset:4608
    ds_read_b64_tr_b16 a[44:45], v117 offset:4096
    ds_read_b64_tr_b16 a[46:47], v117 offset:4608
    s_waitcnt vmcnt(0)
    ds_read_b64_tr_b16 a[48:49], v114 offset:8192
    ds_read_b64_tr_b16 a[50:51], v114 offset:8704
    ds_read_b64_tr_b16 a[52:53], v115 offset:8192
    ds_read_b64_tr_b16 a[54:55], v115 offset:8704
    ds_read_b64_tr_b16 a[56:57], v116 offset:8192
    ds_read_b64_tr_b16 a[58:59], v116 offset:8704
    ds_read_b64_tr_b16 a[60:61], v117 offset:8192
    ds_read_b64_tr_b16 a[62:63], v117 offset:8704
    s_waitcnt lgkmcnt(0)
    s_add_u32 m0, s9, 0
    s_add_u32 s90, s8, 196608
    buffer_load_dwordx4 v112, s[64:67], s90 offen lds
    s_add_u32 m0, s9, 1024
    s_add_u32 s90, s8, 204800
    buffer_load_dwordx4 v113, s[64:67], s90 offen lds
    s_add_u32 m0, s9, 2048
    s_add_u32 s90, s8, 212992
    buffer_load_dwordx4 v112, s[64:67], s90 offen lds
    s_add_u32 m0, s9, 3072
    s_add_u32 s90, s8, 221184
    buffer_load_dwordx4 v113, s[64:67], s90 offen lds
    s_waitcnt vmcnt(0)
    ds_read_b64_tr_b16 a[64:65], v114 offset:0
    ds_read_b64_tr_b16 a[66:67], v114 offset:512
    ds_read_b64_tr_b16 a[68:69], v115 offset:0
    ds_read_b64_tr_b16 a[70:71], v115 offset:512
    ds_read_b64_tr_b16 a[72:73], v116 offset:0
    ds_read_b64_tr_b16 a[74:75], v116 offset:512
    ds_read_b64_tr_b16 a[76:77], v117 offset:0
    ds_read_b64_tr_b16 a[78:79], v117 offset:512
    s_waitcnt lgkmcnt(0)
    s_mov_b32 s91, 0xe0000
    buffer_load_dword v71, v119, s[76:79], s91 offen sc1
    s_waitcnt vmcnt(0)
    v_cmp_ne_u32 vcc, s88, v71
    s_nop 4
    s_cbranch_vccnz L_retry_74
L_back_73:
    buffer_load_dwordx4 a[80:83], v7, s[76:79], s16 offen offset:0 sc1
    buffer_load_dwordx4 a[84:87], v7, s[76:79], s16 offen offset:1024 sc1
    buffer_load_dwordx4 a[88:91], v7, s[76:79], s16 offen offset:2048 sc1
    buffer_load_dwordx4 a[92:95], v7, s[76:79], s16 offen offset:3072 sc1
    buffer_load_dwordx4 a[96:99], v7, s[76:79], s17 offen offset:0 sc1
    buffer_load_dwordx4 a[100:103], v7, s[76:79], s17 offen offset:1024 sc1
    buffer_load_dwordx4 a[104:107], v7, s[76:79], s17 offen offset:2048 sc1
    v_and_b32 v4, 0x3ff, v118
    v_lshlrev_b32 v4, 1, v4
    s_mov_b32 s90, 0x52000
    buffer_load_dwordx4 v[120:123], v4, s[76:79], s90 offen sc1
    s_mov_b32 s90, 0x700000
    buffer_load_dwordx2 v[2:3], v118, s[76:79], s90 offen sc1
    s_mov_b32 s90, 0x710000
    buffer_load_dwordx2 v[124:125], v118, s[76:79], s90 offen sc1
    s_waitcnt vmcnt(0)
    v_max_u32 v71, v120, v121
    v_max3_u32 v71, v71, v122, v123
    v_cmp_eq_u32 vcc, -1, v71
    s_nop 4
    s_cbranch_vccnz L_retry_78
L_back_77:
    s_mov_b32 s91, 0xe8000
    buffer_load_dword v71, v119, s[76:79], s91 offen sc1
    s_waitcnt vmcnt(0)
    s_branch L_g1j_48
L_retry_82:
    s_mov_b32 s94, 0x8000
L_again_79:
    s_mov_b64 exec, vcc
    buffer_load_dword v71, v119, s[76:79], s91 offen sc1
    s_waitcnt vmcnt(0)
    v_cmp_ne_u32 vcc, s88, v71
    s_nop 4
    s_cbranch_vccz L_arrived_80
    s_sub_u32 s94, s94, 1
    s_cmp_lg_u32 s94, 0
    s_cbranch_scc1 L_again_79
L_arrived_80:
    s_mov_b64 exec, -1
    s_branch L_back_81
L_retry_86:
    s_mov_b32 s94, 0x8000
L_again_83:
    s_mov_b64 exec, vcc
    buffer_load_dword v71, v119, s[76:79], s91 offen sc1
    s_waitcnt vmcnt(0)
    v_cmp_ne_u32 vcc, s88, v71
    s_nop 4
    s_cbranch_vccz L_arrived_84
    s_sub_u32 s94, s94, 1
    s_cmp_lg_u32 s94, 0
    s_cbranch_scc1 L_again_83
L_arrived_84:
    s_mov_b64 exec, -1
    s_branch L_back_85
L_retry_90:
    s_mov_b32 s94, 0x8000
L_again_87:
    s_mov_b64 exec, vcc
    buffer_load_dword v71, v119, s[76:79], s91 offen sc1
    s_waitcnt vmcnt(0)
    v_cmp_ne_u32 vcc, s88, v71
    s_nop 4
    s_cbranch_vccz L_arrived_88
    s_sub_u32 s94, s94, 1
    s_cmp_lg_u32 s94, 0
    s_cbranch_scc1 L_again_87
L_arrived_88:
    s_mov_b64 exec, -1
    s_branch L_back_89
L_last:
    s_endpgm
.section .rodata,"a"
.p2align 6
.amdhsa_kernel adaLN_cond__ssm_conv_h3__glu_gated_geglu__prompt_kernel
  .amdhsa_next_free_vgpr 256
  .amdhsa_next_free_sgpr 102
  .amdhsa_accum_offset 128
  .amdhsa_group_segment_fixed_size 0
  .amdhsa_kernarg_size 120
  .amdhsa_user_sgpr_count 2
  .amdhsa_user_sgpr_kernarg_segment_ptr 1
  .amdhsa_system_sgpr_workgroup_id_x 1
.end_amdhsa_kernel
```
